```python
import torch

def _softmax(x, axis=-1):
    return torch.softmax(x, dim=axis)
def _gelu(x):
    return torch.nn.functional.gelu(x, approximate="tanh")
def _silu(x):
    return torch.nn.functional.silu(x)
def _sigmoid(x):
    return torch.sigmoid(x)
def _layernorm(x, axis=-1, eps=1e-5):
    m = x.mean(dim=axis, keepdim=True)
    v = x.var(dim=axis, keepdim=True, unbiased=False)
    return (x - m) / torch.sqrt(v + eps)
def _scatter_add(tgt, idx, src, axis=0):
    return tgt.clone().index_add_(axis, idx, src)
def _segment_sum(src, seg, n):
    out = torch.zeros((n,) + src.shape[1:], dtype=src.dtype)
    return out.index_add_(0, seg, src)
def _pad(x, pw):
    flat = tuple(v for pair in reversed(pw) for v in pair)
    return torch.nn.functional.pad(x, flat)

kernel_name = 'standalone__detection_seg_fpn_lateral__vision'

def setup_inputs():

    _w = (lambda a: (lambda t: t.to(torch.bfloat16) if t.is_floating_point() else t)(torch.as_tensor(a)))
    H = W = (384 // 2) * 2
    C = 96
    k = 3
    return {
        "c_fine": _w((lambda *s: torch.randn(*s, dtype=torch.bfloat16) * 0.05)(1, H, W, C)),
        "p_coarse": _w((lambda *s: torch.randn(*s, dtype=torch.bfloat16) * 0.05)(1, H // 2, W // 2, C)),
        "w_lat": _w((lambda *s: torch.randn(*s, dtype=torch.bfloat16) * 0.05)(C, C)),
        "w_out": _w((lambda *s: torch.randn(*s, dtype=torch.bfloat16) * 0.05)(k, k, C, C)),
    }

def reference(c_fine, p_coarse, w_lat, w_out):
    B, H, W, C = c_fine.shape
    k = 3
    lat = torch.einsum("bhwc,cd->bhwd", c_fine, w_lat)
    up = (lambda x, n, axis: torch.repeat_interleave(x, n, dim=axis))((lambda x, n, axis: torch.repeat_interleave(x, n, dim=axis))(p_coarse, 2, axis=1), 2, axis=2)
    m = lat + up
    pad = k // 2
    mp = _pad(m, ((0, 0), (pad, pad), (pad, pad), (0, 0)))
    o = None
    for di in range(k):
        for dj in range(k):
            t = torch.einsum("bhwc,cd->bhwd", mp[:, di:di + H, dj:dj + W, :], w_out[di, dj])
            o = t if o is None else o + t
    return o
```

```asm
; @launch grid=(256,1,1) block=(256,1,1) lds=163840
.amdgcn_target "amdgcn-amd-amdhsa--gfx950"
.text
.globl standalone__detection_seg_fpn_lateral__vision_kernel
.p2align 8
.type standalone__detection_seg_fpn_lateral__vision_kernel,@function
standalone__detection_seg_fpn_lateral__vision_kernel:
    s_cmp_ge_u32 s2, 256
    s_cbranch_scc1 L_end
    s_load_dwordx8 s[40:47], s[0:1], 0
    s_load_dwordx2 s[48:49], s[0:1], 32
    v_and_b32 v244, 63, v0
    v_lshrrev_b32 v247, 6, v0
    v_and_b32 v245, 15, v244
    v_lshrrev_b32 v246, 4, v244
    v_readfirstlane_b32 s24, v247
    v_lshlrev_b32 v1, 4, v244
    s_nop 2
    s_and_b32 s25, s24, 1
    s_lshr_b32 s26, s24, 1
    s_lshr_b32 s27, s2, 3
    s_and_b32 s28, s2, 7
    s_mul_i32 s29, s27, 12
    s_mul_i32 s38, s28, 9216
    s_mul_i32 s39, s25, 96
    s_mul_i32 s50, s26, 9600
    s_mul_i32 s51, s28, 4608
    s_mul_i32 s61, s24, 4608
    s_mul_i32 s60, s25, 4608
    s_add_u32 s60, s60, s50
    s_add_u32 s60, s60, 192
    s_lshl_b32 s62, s24, 10
    s_lshl_b32 s63, s24, 7
    s_add_u32 s63, s63, 4096
    s_waitcnt lgkmcnt(0)
    s_mov_b32 s4, s40
    s_and_b32 s5, s41, 0xffff
    s_mov_b32 s6, 0x1b00000
    s_mov_b32 s7, 0x00020000
    s_mov_b32 s8, s42
    s_and_b32 s9, s43, 0xffff
    s_mov_b32 s10, 0x6c0000
    s_mov_b32 s11, 0x00020000
    s_mov_b32 s12, s44
    s_and_b32 s13, s45, 0xffff
    s_mov_b32 s14, 0x4800
    s_mov_b32 s15, 0x00020000
    s_mov_b32 s16, s46
    s_and_b32 s17, s47, 0xffff
    s_mov_b32 s18, 0x28800
    s_mov_b32 s19, 0x00020000
    s_mov_b32 s20, s48
    s_and_b32 s21, s49, 0xffff
    s_mov_b32 s22, 0x1b00000
    s_mov_b32 s23, 0x00020000
    s_and_b32 s42, s27, 1
    s_mul_i32 s56, s42, 110592
    s_lshl_b32 s41, s42, 1
    s_sub_u32 s41, 1, s41
    s_mul_i32 s40, s42, 13
    s_add_u32 s40, s40, s29
    s_sub_u32 s40, s40, 1
    s_mul_i32 s57, s41, 147456
    s_mul_i32 s58, s41, 36864
    s_mul_i32 s52, s41, s26
    s_add_u32 s52, s52, s40
    s_mul_i32 s30, s52, 73728
    s_mul_i32 s53, s25, 4608
    s_add_u32 s30, s30, s53
    s_add_u32 s30, s30, s38
    s_mov_b32 s31, 0
    s_mul_i32 s53, s27, 6
    s_mul_i32 s54, s42, 7
    s_add_u32 s53, s53, s54
    s_sub_u32 s53, s53, 1
    s_mul_i32 s32, s53, 36864
    s_add_u32 s32, s32, s51
    s_mov_b32 s33, 134592
    s_add_u32 s54, s52, s41
    s_mul_i32 s34, s54, 73728
    s_add_u32 s35, s34, 3072
    s_add_u32 s36, s34, 6144
    s_sub_u32 s36, s36, s57
    s_add_u32 m0, s60, 38400
    s_mov_b32 s55, s61
    buffer_load_dwordx4 v1, s[12:15], s55 offen offset:0 lds
    buffer_load_dwordx4 v1, s[12:15], s55 offen offset:1024 lds
    buffer_load_dwordx4 v1, s[12:15], s55 offen offset:2048 lds
    buffer_load_dwordx4 v1, s[12:15], s55 offen offset:3072 lds
    s_add_u32 m0, m0, 4096
    s_add_u32 s55, s55, 4096
    s_mov_b64 exec, 0xffffffff
    buffer_load_dwordx4 v1, s[12:15], s55 offen lds
    s_mov_b64 exec, -1
    s_mov_b32 s54, s30
    s_cmp_lt_i32 s30, 0
    s_cselect_b32 s30, 0x40000000, s30
    s_add_u32 m0, s60, s31
    s_nop 0
    buffer_load_dwordx4 v1, s[4:7], s30 offen offset:0 nt lds
    buffer_load_dwordx4 v1, s[4:7], s30 offen offset:1024 nt lds
    buffer_load_dwordx4 v1, s[4:7], s30 offen offset:2048 nt lds
    buffer_load_dwordx4 v1, s[4:7], s30 offen offset:3072 nt lds
    s_add_u32 m0, m0, 4096
    s_add_u32 s55, s30, 4096
    s_mov_b64 exec, 0xffffffff
    buffer_load_dwordx4 v1, s[4:7], s55 offen nt lds
    s_mov_b64 exec, -1
    s_mov_b32 s30, s54
    s_add_u32 s30, s30, s57
    s_add_u32 s31, s31, 19200
    s_mov_b32 s54, s32
    s_cmp_lt_i32 s32, 0
    s_cselect_b32 s32, 0x40000000, s32
    s_add_u32 m0, s33, s62
    s_add_u32 s55, s32, s62
    buffer_load_dwordx4 v1, s[8:11], s55 offen nt lds
    s_add_u32 m0, s33, s63
    s_add_u32 s55, s32, s63
    s_mov_b64 exec, 0xff
    buffer_load_dwordx4 v1, s[8:11], s55 offen nt lds
    s_mov_b64 exec, -1
    s_mov_b32 s32, s54
    s_add_u32 s32, s32, s58
    s_add_u32 s33, s33, 4608
    s_cmp_eq_u32 s33, 162240
    s_cselect_b32 s33, 134592, s33
    s_add_u32 m0, s33, s62
    s_add_u32 s55, s32, s62
    buffer_load_dwordx4 v1, s[8:11], s55 offen nt lds
    s_add_u32 m0, s33, s63
    s_add_u32 s55, s32, s63
    s_mov_b64 exec, 0xff
    buffer_load_dwordx4 v1, s[8:11], s55 offen nt lds
    s_mov_b64 exec, -1
    s_add_u32 s32, s32, s58
    s_add_u32 s33, s33, 4608
    s_cmp_eq_u32 s33, 162240
    s_cselect_b32 s33, 134592, s33
    s_add_u32 m0, s60, s31
    s_nop 0
    buffer_load_dwordx4 v1, s[4:7], s30 offen offset:0 nt lds
    buffer_load_dwordx4 v1, s[4:7], s30 offen offset:1024 nt lds
    buffer_load_dwordx4 v1, s[4:7], s30 offen offset:2048 nt lds
    buffer_load_dwordx4 v1, s[4:7], s30 offen offset:3072 nt lds
    s_add_u32 m0, m0, 4096
    s_add_u32 s55, s30, 4096
    s_mov_b64 exec, 0xffffffff
    buffer_load_dwordx4 v1, s[4:7], s55 offen nt lds
    s_mov_b64 exec, -1
    s_add_u32 s30, s30, s57
    s_add_u32 s31, s31, 19200
    s_add_u32 m0, s33, s62
    s_add_u32 s55, s32, s62
    buffer_load_dwordx4 v1, s[8:11], s55 offen nt lds
    s_add_u32 m0, s33, s63
    s_add_u32 s55, s32, s63
    s_mov_b64 exec, 0xff
    buffer_load_dwordx4 v1, s[8:11], s55 offen nt lds
    s_mov_b64 exec, -1
    s_add_u32 s32, s32, s58
    s_add_u32 s33, s33, 4608
    s_cmp_eq_u32 s33, 162240
    s_cselect_b32 s33, 134592, s33
    v_mul_u32_u24 v247, 192, v245
    v_lshl_add_u32 v248, v246, 4, v247
    v_add_u32 v5, s38, v248
    v_add_u32 v5, s39, v5
    v_add_u32 v3, s50, v248
    v_add_u32 v3, 192, v3
    v_lshrrev_b32 v248, 1, v245
    v_mul_u32_u24 v248, 192, v248
    s_mul_i32 s53, s26, 4608
    s_add_u32 s53, s53, 134592
    s_add_u32 s53, s53, s39
    v_add_u32 v248, s53, v248
    v_lshl_add_u32 v4, v246, 4, v248
    v_lshl_add_u32 v11, v246, 3, v248
    v_add_u32 v11, 64, v11
    s_mul_i32 s52, s28, 48
    s_mul_i32 s53, s26, 49
    s_add_u32 s52, s52, s53
    s_sub_u32 s52, s52, 1
    v_mul_lo_u32 v248, v245, s41
    v_add_u32 v248, s40, v248
    v_cmp_gt_u32 vcc, 0x180, v248
    v_cmp_gt_u32 s[44:45], 14, v245
    s_and_b64 vcc, vcc, s[44:45]
    s_cmp_lt_u32 s52, 384
    s_cselect_b64 s[46:47], -1, 0
    s_and_b64 vcc, vcc, s[46:47]
    v_mul_u32_u24 v249, 384, v248
    v_add_u32 v249, s52, v249
    v_mul_u32_u24 v249, 192, v249
    v_lshl_add_u32 v249, v246, 4, v249
    v_mov_b32 v250, 0x40000000
    v_cndmask_b32 v66, v250, v249, vcc
    v_lshrrev_b32 v249, 1, v248
    v_mul_u32_u24 v249, 192, v249
    s_lshr_b32 s53, s52, 1
    v_add_u32 v249, s53, v249
    v_mul_u32_u24 v249, 192, v249
    v_add_u32 v249, s39, v249
    v_lshl_add_u32 v251, v246, 4, v249
    v_cndmask_b32 v67, v250, v251, vcc
    v_lshl_add_u32 v251, v246, 3, v249
    v_add_u32 v251, 64, v251
    v_cndmask_b32 v68, v250, v251, vcc
    v_mul_u32_u24 v249, 9600, v245
    s_mul_i32 s53, s26, 9408
    v_add_u32 v249, s53, v249
    v_mov_b32 v250, 0x20d00
    v_cndmask_b32 v249, v250, v249, s[44:45]
    v_add_u32 v249, s39, v249
    v_lshl_add_u32 v69, v246, 4, v249
    v_lshl_add_u32 v70, v246, 3, v249
    v_add_u32 v70, 64, v70
    v_add_u32 v248, 0, v245
    v_bfe_u32 v249, v248, 2, 1
    v_lshlrev_b32 v249, 5, v249
    v_lshlrev_b32 v250, 4, v246
    v_xor_b32 v249, v249, v250
    v_mul_u32_u24 v248, 192, v248
    v_add3_u32 v6, v248, v249, s50
    v_add_u32 v248, 1, v245
    v_bfe_u32 v249, v248, 2, 1
    v_lshlrev_b32 v249, 5, v249
    v_lshlrev_b32 v250, 4, v246
    v_xor_b32 v249, v249, v250
    v_mul_u32_u24 v248, 192, v248
    v_add3_u32 v7, v248, v249, s50
    v_add_u32 v248, 2, v245
    v_bfe_u32 v249, v248, 2, 1
    v_lshlrev_b32 v249, 5, v249
    v_lshlrev_b32 v250, 4, v246
    v_xor_b32 v249, v249, v250
    v_mul_u32_u24 v248, 192, v248
    v_add3_u32 v8, v248, v249, s50
    v_add_u32 v248, 1, v245
    v_bfe_u32 v249, v248, 2, 1
    v_lshlrev_b32 v249, 5, v249
    v_mul_u32_u24 v248, 192, v248
    v_lshlrev_b32 v250, 4, v246
    v_add_u32 v250, s39, v250
    v_xor_b32 v250, v250, v249
    v_add3_u32 v9, v248, v250, s50
    v_lshlrev_b32 v250, 3, v246
    v_add_u32 v250, s39, v250
    v_add_u32 v250, 64, v250
    v_xor_b32 v250, v250, v249
    v_add3_u32 v10, v248, v250, s50
    v_lshrrev_b32 v248, 2, v245
    v_lshl_add_u32 v248, v246, 3, v248
    v_mul_u32_u24 v248, 192, v248
    v_add_u32 v248, s39, v248
    v_add_u32 v248, 0x96c0, v248
    v_and_b32 v249, 3, v245
    v_lshl_add_u32 v138, v249, 4, v248
    v_lshl_add_u32 v0, v249, 3, v248
    v_add_u32 v0, 64, v0
    v_lshrrev_b32 v249, 1, v246
    v_mul_u32_u24 v249, 384, v249
    v_add_u32 v139, v138, v249
    v_add_u32 v2, v0, v249
    buffer_load_dwordx4 v[48:51], v66, s[4:7], 0 offen offset:0
    buffer_load_dwordx4 v[52:55], v66, s[4:7], 0 offen offset:64
    buffer_load_dwordx4 v[56:59], v66, s[4:7], 0 offen offset:128
    buffer_load_dwordx4 v[60:63], v67, s[8:11], 0 offen
    buffer_load_dwordx2 v[64:65], v68, s[8:11], 0 offen
    s_waitcnt vmcnt(12)
    s_barrier
    ds_read_b128 v[120:123], v4 offset:0
    ds_read_b64 v[124:125], v11 offset:0
    ds_read_b128 v[126:129], v4 offset:1536
    ds_read_b64 v[130:131], v11 offset:1536
    ds_read_b128 v[132:135], v4 offset:3072
    ds_read_b64 v[136:137], v11 offset:3072
    ds_read_b128 v[84:87], v3 offset:0
    ds_read_b128 v[88:91], v3 offset:64
    ds_read_b128 v[92:95], v3 offset:128
    ds_read_b64_tr_b16 v[140:141], v138 offset:0
    ds_read_b64_tr_b16 v[142:143], v138 offset:768
    ds_read_b64_tr_b16 v[144:145], v138 offset:8
    ds_read_b64_tr_b16 v[146:147], v138 offset:776
    ds_read_b64_tr_b16 v[148:149], v0 offset:0
    ds_read_b64_tr_b16 v[150:151], v0 offset:768
    ds_read_b64_tr_b16 v[152:153], v139 offset:6144
    ds_read_b64_tr_b16 v[154:155], v139 offset:6912
    ds_read_b64_tr_b16 v[156:157], v139 offset:6152
    ds_read_b64_tr_b16 v[158:159], v139 offset:6920
    ds_read_b64_tr_b16 v[160:161], v2 offset:6144
    ds_read_b64_tr_b16 v[162:163], v2 offset:6912
    ds_read_b64_tr_b16 v[164:165], v138 offset:12672
    ds_read_b64_tr_b16 v[166:167], v138 offset:13440
    ds_read_b64_tr_b16 v[168:169], v138 offset:12680
    ds_read_b64_tr_b16 v[170:171], v138 offset:13448
    ds_read_b64_tr_b16 v[172:173], v0 offset:12672
    ds_read_b64_tr_b16 v[174:175], v0 offset:13440
    ds_read_b128 v[96:99], v3 offset:3072
    ds_read_b128 v[100:103], v3 offset:3136
    ds_read_b128 v[104:107], v3 offset:3200
    ds_read_b128 v[108:111], v3 offset:6144
    ds_read_b128 v[112:115], v3 offset:6208
    ds_read_b128 v[116:119], v3 offset:6272
    s_waitcnt lgkmcnt(15)
    v_lshlrev_b32 v72, 16, v120
    v_and_b32 v73, 0xffff0000, v120
    v_lshlrev_b32 v74, 16, v121
    v_and_b32 v75, 0xffff0000, v121
    v_lshlrev_b32 v76, 16, v122
    v_and_b32 v77, 0xffff0000, v122
    v_lshlrev_b32 v78, 16, v123
    v_and_b32 v79, 0xffff0000, v123
    v_lshlrev_b32 v80, 16, v124
    v_and_b32 v81, 0xffff0000, v124
    v_lshlrev_b32 v82, 16, v125
    v_and_b32 v83, 0xffff0000, v125
    s_waitcnt lgkmcnt(6)
    v_mfma_f32_16x16x32_bf16 v[72:75], v[140:143], v[84:87], v[72:75]
    v_mfma_f32_16x16x32_bf16 v[76:79], v[144:147], v[84:87], v[76:79]
    v_mfma_f32_16x16x32_bf16 v[80:83], v[148:151], v[84:87], v[80:83]
    v_mfma_f32_16x16x32_bf16 v[72:75], v[152:155], v[88:91], v[72:75]
    v_mfma_f32_16x16x32_bf16 v[76:79], v[156:159], v[88:91], v[76:79]
    v_mfma_f32_16x16x32_bf16 v[80:83], v[160:163], v[88:91], v[80:83]
    v_lshlrev_b32 v244, 16, v126
    v_and_b32 v245, 0xffff0000, v126
    v_lshlrev_b32 v246, 16, v127
    v_and_b32 v247, 0xffff0000, v127
    v_lshlrev_b32 v248, 16, v128
    v_mfma_f32_16x16x32_bf16 v[72:75], v[164:167], v[92:95], v[72:75]
    v_and_b32 v249, 0xffff0000, v128
    v_lshlrev_b32 v250, 16, v129
    v_and_b32 v251, 0xffff0000, v129
    v_lshlrev_b32 v252, 16, v130
    v_mfma_f32_16x16x32_bf16 v[76:79], v[168:171], v[92:95], v[76:79]
    v_and_b32 v253, 0xffff0000, v130
    v_lshlrev_b32 v254, 16, v131
    v_and_b32 v255, 0xffff0000, v131
    v_mfma_f32_16x16x32_bf16 v[80:83], v[172:175], v[92:95], v[80:83]
    s_add_u32 m0, s60, 115200
    s_add_u32 s55, s61, 0
    s_add_u32 s55, s55, s56
    buffer_load_dwordx4 v1, s[16:19], s55 offen offset:0 lds
    buffer_load_dwordx4 v1, s[16:19], s55 offen offset:1024 lds
    buffer_load_dwordx4 v1, s[16:19], s55 offen offset:2048 lds
    buffer_load_dwordx4 v1, s[16:19], s55 offen offset:3072 lds
    s_add_u32 m0, m0, 4096
    s_add_u32 s55, s55, 4096
    s_mov_b64 exec, 0xffffffff
    buffer_load_dwordx4 v1, s[16:19], s55 offen lds
    s_mov_b64 exec, -1
    s_nop 0
    s_waitcnt lgkmcnt(0)
    v_mfma_f32_16x16x32_bf16 v[244:247], v[140:143], v[96:99], v[244:247]
    v_mfma_f32_16x16x32_bf16 v[248:251], v[144:147], v[96:99], v[248:251]
    s_waitcnt vmcnt(10)
    s_barrier
    ds_read_b128 v[12:15], v3 offset:19200
    ds_read_b128 v[16:19], v3 offset:19264
    ds_read_b128 v[20:23], v3 offset:19328
    ds_read_b128 v[24:27], v3 offset:22272
    ds_read_b128 v[28:31], v3 offset:22336
    v_mfma_f32_16x16x32_bf16 v[252:255], v[148:151], v[96:99], v[252:255]
    ds_read_b128 v[32:35], v3 offset:22400
    ds_read_b128 v[36:39], v3 offset:25344
    ds_read_b128 v[40:43], v3 offset:25408
    ds_read_b128 v[44:47], v3 offset:25472
    v_mfma_f32_16x16x32_bf16 v[244:247], v[152:155], v[100:103], v[244:247]
    v_cvt_pk_bf16_f32 v72, v72, v73
    v_cvt_pk_bf16_f32 v73, v74, v75
    v_cvt_pk_bf16_f32 v74, v76, v77
    v_cvt_pk_bf16_f32 v75, v78, v79
    v_mfma_f32_16x16x32_bf16 v[248:251], v[156:159], v[100:103], v[248:251]
    v_cvt_pk_bf16_f32 v80, v80, v81
    v_cvt_pk_bf16_f32 v81, v82, v83
    ds_write_b128 v9, v[72:75] offset:0
    ds_write_b64 v10, v[80:81] offset:0
    v_mfma_f32_16x16x32_bf16 v[252:255], v[160:163], v[100:103], v[252:255]
    v_lshlrev_b32 v72, 16, v132
    v_and_b32 v73, 0xffff0000, v132
    v_lshlrev_b32 v74, 16, v133
    v_and_b32 v75, 0xffff0000, v133
    v_lshlrev_b32 v76, 16, v134
    v_mfma_f32_16x16x32_bf16 v[244:247], v[164:167], v[104:107], v[244:247]
    v_and_b32 v77, 0xffff0000, v134
    v_lshlrev_b32 v78, 16, v135
    v_and_b32 v79, 0xffff0000, v135
    v_lshlrev_b32 v80, 16, v136
    v_mfma_f32_16x16x32_bf16 v[248:251], v[168:171], v[104:107], v[248:251]
    v_and_b32 v81, 0xffff0000, v136
    v_lshlrev_b32 v82, 16, v137
    v_and_b32 v83, 0xffff0000, v137
    v_mfma_f32_16x16x32_bf16 v[252:255], v[172:175], v[104:107], v[252:255]
    s_add_u32 m0, s60, 96000
    s_add_u32 s55, s61, 18432
    s_add_u32 s55, s55, s56
    buffer_load_dwordx4 v1, s[16:19], s55 offen offset:0 lds
    buffer_load_dwordx4 v1, s[16:19], s55 offen offset:1024 lds
    buffer_load_dwordx4 v1, s[16:19], s55 offen offset:2048 lds
    buffer_load_dwordx4 v1, s[16:19], s55 offen offset:3072 lds
    s_add_u32 m0, m0, 4096
    s_add_u32 s55, s55, 4096
    s_mov_b64 exec, 0xffffffff
    buffer_load_dwordx4 v1, s[16:19], s55 offen lds
    s_mov_b64 exec, -1
    s_nop 0
    v_mfma_f32_16x16x32_bf16 v[72:75], v[140:143], v[108:111], v[72:75]
    v_mfma_f32_16x16x32_bf16 v[76:79], v[144:147], v[108:111], v[76:79]
    v_mfma_f32_16x16x32_bf16 v[80:83], v[148:151], v[108:111], v[80:83]
    v_mfma_f32_16x16x32_bf16 v[72:75], v[152:155], v[112:115], v[72:75]
    v_cvt_pk_bf16_f32 v244, v244, v245
    v_cvt_pk_bf16_f32 v245, v246, v247
    v_cvt_pk_bf16_f32 v246, v248, v249
    v_cvt_pk_bf16_f32 v247, v250, v251
    v_mfma_f32_16x16x32_bf16 v[76:79], v[156:159], v[112:115], v[76:79]
    v_cvt_pk_bf16_f32 v252, v252, v253
    v_cvt_pk_bf16_f32 v253, v254, v255
    ds_write_b128 v9, v[244:247] offset:3072
    ds_write_b64 v10, v[252:253] offset:3072
    v_mfma_f32_16x16x32_bf16 v[80:83], v[160:163], v[112:115], v[80:83]
    ds_read_b128 v[120:123], v4 offset:4608
    ds_read_b64 v[124:125], v11 offset:4608
    ds_read_b128 v[126:129], v4 offset:6144
    ds_read_b64 v[130:131], v11 offset:6144
    ds_read_b128 v[132:135], v4 offset:7680
    ds_read_b64 v[136:137], v11 offset:7680
    s_waitcnt vmcnt(10)
    v_lshlrev_b32 v244, 16, v60
    v_and_b32 v245, 0xffff0000, v60
    v_lshlrev_b32 v246, 16, v61
    v_and_b32 v247, 0xffff0000, v61
    v_mfma_f32_16x16x32_bf16 v[72:75], v[164:167], v[116:119], v[72:75]
    v_lshlrev_b32 v248, 16, v62
    v_and_b32 v249, 0xffff0000, v62
    v_lshlrev_b32 v250, 16, v63
    v_and_b32 v251, 0xffff0000, v63
    v_mfma_f32_16x16x32_bf16 v[76:79], v[168:171], v[116:119], v[76:79]
    v_lshlrev_b32 v252, 16, v64
    v_and_b32 v253, 0xffff0000, v64
    v_lshlrev_b32 v254, 16, v65
    v_and_b32 v255, 0xffff0000, v65
    v_mfma_f32_16x16x32_bf16 v[80:83], v[172:175], v[116:119], v[80:83]
    s_add_u32 m0, s60, 76800
    s_add_u32 s55, s61, 36864
    s_add_u32 s55, s55, s56
    buffer_load_dwordx4 v1, s[16:19], s55 offen offset:0 lds
    buffer_load_dwordx4 v1, s[16:19], s55 offen offset:1024 lds
    buffer_load_dwordx4 v1, s[16:19], s55 offen offset:2048 lds
    buffer_load_dwordx4 v1, s[16:19], s55 offen offset:3072 lds
    s_add_u32 m0, m0, 4096
    s_add_u32 s55, s55, 4096
    s_mov_b64 exec, 0xffffffff
    buffer_load_dwordx4 v1, s[16:19], s55 offen lds
    s_mov_b64 exec, -1
    s_nop 0
    v_mfma_f32_16x16x32_bf16 v[244:247], v[140:143], v[48:51], v[244:247]
    v_mfma_f32_16x16x32_bf16 v[248:251], v[144:147], v[48:51], v[248:251]
    v_mfma_f32_16x16x32_bf16 v[252:255], v[148:151], v[48:51], v[252:255]
    v_mfma_f32_16x16x32_bf16 v[244:247], v[152:155], v[52:55], v[244:247]
    v_cvt_pk_bf16_f32 v72, v72, v73
    v_cvt_pk_bf16_f32 v73, v74, v75
    v_cvt_pk_bf16_f32 v74, v76, v77
    v_cvt_pk_bf16_f32 v75, v78, v79
    v_mfma_f32_16x16x32_bf16 v[248:251], v[156:159], v[52:55], v[248:251]
    v_cvt_pk_bf16_f32 v80, v80, v81
    v_cvt_pk_bf16_f32 v81, v82, v83
    ds_write_b128 v9, v[72:75] offset:6144
    ds_write_b64 v10, v[80:81] offset:6144
    v_mfma_f32_16x16x32_bf16 v[252:255], v[160:163], v[52:55], v[252:255]
    s_waitcnt lgkmcnt(2)
    v_lshlrev_b32 v72, 16, v120
    v_and_b32 v73, 0xffff0000, v120
    v_lshlrev_b32 v74, 16, v121
    v_and_b32 v75, 0xffff0000, v121
    v_mfma_f32_16x16x32_bf16 v[244:247], v[164:167], v[56:59], v[244:247]
    v_lshlrev_b32 v76, 16, v122
    v_and_b32 v77, 0xffff0000, v122
    v_lshlrev_b32 v78, 16, v123
    v_and_b32 v79, 0xffff0000, v123
    v_mfma_f32_16x16x32_bf16 v[248:251], v[168:171], v[56:59], v[248:251]
    v_lshlrev_b32 v80, 16, v124
    v_and_b32 v81, 0xffff0000, v124
    v_lshlrev_b32 v82, 16, v125
    v_and_b32 v83, 0xffff0000, v125
    v_mfma_f32_16x16x32_bf16 v[252:255], v[172:175], v[56:59], v[252:255]
    s_add_u32 m0, s60, 57600
    s_add_u32 s55, s61, 55296
    buffer_load_dwordx4 v1, s[16:19], s55 offen offset:0 lds
    buffer_load_dwordx4 v1, s[16:19], s55 offen offset:1024 lds
    buffer_load_dwordx4 v1, s[16:19], s55 offen offset:2048 lds
    buffer_load_dwordx4 v1, s[16:19], s55 offen offset:3072 lds
    s_add_u32 m0, m0, 4096
    s_add_u32 s55, s55, 4096
    s_mov_b64 exec, 0xffffffff
    buffer_load_dwordx4 v1, s[16:19], s55 offen lds
    s_mov_b64 exec, -1
    s_nop 0
    v_mfma_f32_16x16x32_bf16 v[72:75], v[140:143], v[12:15], v[72:75]
    v_mfma_f32_16x16x32_bf16 v[76:79], v[144:147], v[12:15], v[76:79]
    v_mfma_f32_16x16x32_bf16 v[80:83], v[148:151], v[12:15], v[80:83]
    v_mfma_f32_16x16x32_bf16 v[72:75], v[152:155], v[16:19], v[72:75]
    v_cvt_pk_bf16_f32 v244, v244, v245
    v_cvt_pk_bf16_f32 v245, v246, v247
    v_cvt_pk_bf16_f32 v246, v248, v249
    v_cvt_pk_bf16_f32 v247, v250, v251
    v_mfma_f32_16x16x32_bf16 v[76:79], v[156:159], v[16:19], v[76:79]
    v_cvt_pk_bf16_f32 v252, v252, v253
    v_cvt_pk_bf16_f32 v253, v254, v255
    ds_write_b128 v69, v[244:247] offset:0
    ds_write_b64 v70, v[252:253] offset:0
    v_mfma_f32_16x16x32_bf16 v[80:83], v[160:163], v[16:19], v[80:83]
    v_lshlrev_b32 v244, 16, v126
    v_and_b32 v245, 0xffff0000, v126
    v_lshlrev_b32 v246, 16, v127
    v_and_b32 v247, 0xffff0000, v127
    v_lshlrev_b32 v248, 16, v128
    v_mfma_f32_16x16x32_bf16 v[72:75], v[164:167], v[20:23], v[72:75]
    v_and_b32 v249, 0xffff0000, v128
    v_lshlrev_b32 v250, 16, v129
    v_and_b32 v251, 0xffff0000, v129
    v_lshlrev_b32 v252, 16, v130
    v_mfma_f32_16x16x32_bf16 v[76:79], v[168:171], v[20:23], v[76:79]
    v_and_b32 v253, 0xffff0000, v130
    v_lshlrev_b32 v254, 16, v131
    v_and_b32 v255, 0xffff0000, v131
    v_mfma_f32_16x16x32_bf16 v[80:83], v[172:175], v[20:23], v[80:83]
    s_nop 0
    v_mfma_f32_16x16x32_bf16 v[244:247], v[140:143], v[24:27], v[244:247]
    v_mfma_f32_16x16x32_bf16 v[248:251], v[144:147], v[24:27], v[248:251]
    s_barrier
    v_mfma_f32_16x16x32_bf16 v[252:255], v[148:151], v[24:27], v[252:255]
    v_mfma_f32_16x16x32_bf16 v[244:247], v[152:155], v[28:31], v[244:247]
    v_cvt_pk_bf16_f32 v72, v72, v73
    v_cvt_pk_bf16_f32 v73, v74, v75
    v_cvt_pk_bf16_f32 v74, v76, v77
    v_cvt_pk_bf16_f32 v75, v78, v79
    v_mfma_f32_16x16x32_bf16 v[248:251], v[156:159], v[28:31], v[248:251]
    v_cvt_pk_bf16_f32 v80, v80, v81
    v_cvt_pk_bf16_f32 v81, v82, v83
    ds_write_b128 v9, v[72:75] offset:19200
    ds_write_b64 v10, v[80:81] offset:19200
    v_mfma_f32_16x16x32_bf16 v[252:255], v[160:163], v[28:31], v[252:255]
    v_lshlrev_b32 v72, 16, v132
    v_and_b32 v73, 0xffff0000, v132
    v_lshlrev_b32 v74, 16, v133
    v_and_b32 v75, 0xffff0000, v133
    v_lshlrev_b32 v76, 16, v134
    v_mfma_f32_16x16x32_bf16 v[244:247], v[164:167], v[32:35], v[244:247]
    v_and_b32 v77, 0xffff0000, v134
    v_lshlrev_b32 v78, 16, v135
    v_and_b32 v79, 0xffff0000, v135
    v_lshlrev_b32 v80, 16, v136
    v_mfma_f32_16x16x32_bf16 v[248:251], v[168:171], v[32:35], v[248:251]
    v_and_b32 v81, 0xffff0000, v136
    v_lshlrev_b32 v82, 16, v137
    v_and_b32 v83, 0xffff0000, v137
    v_mfma_f32_16x16x32_bf16 v[252:255], v[172:175], v[32:35], v[252:255]
    s_nop 0
    v_mfma_f32_16x16x32_bf16 v[72:75], v[140:143], v[36:39], v[72:75]
    v_mfma_f32_16x16x32_bf16 v[76:79], v[144:147], v[36:39], v[76:79]
    v_mfma_f32_16x16x32_bf16 v[80:83], v[148:151], v[36:39], v[80:83]
    v_mfma_f32_16x16x32_bf16 v[72:75], v[152:155], v[40:43], v[72:75]
    v_cvt_pk_bf16_f32 v244, v244, v245
    v_cvt_pk_bf16_f32 v245, v246, v247
    v_cvt_pk_bf16_f32 v246, v248, v249
    v_cvt_pk_bf16_f32 v247, v250, v251
    v_mfma_f32_16x16x32_bf16 v[76:79], v[156:159], v[40:43], v[76:79]
    v_cvt_pk_bf16_f32 v252, v252, v253
    v_cvt_pk_bf16_f32 v253, v254, v255
    ds_write_b128 v9, v[244:247] offset:22272
    ds_write_b64 v10, v[252:253] offset:22272
    v_mfma_f32_16x16x32_bf16 v[80:83], v[160:163], v[40:43], v[80:83]
    v_mfma_f32_16x16x32_bf16 v[72:75], v[164:167], v[44:47], v[72:75]
    v_mfma_f32_16x16x32_bf16 v[76:79], v[168:171], v[44:47], v[76:79]
    v_mfma_f32_16x16x32_bf16 v[80:83], v[172:175], v[44:47], v[80:83]
    s_nop 0
    s_nop 7
    v_cvt_pk_bf16_f32 v72, v72, v73
    v_cvt_pk_bf16_f32 v73, v74, v75
    v_cvt_pk_bf16_f32 v74, v76, v77
    v_cvt_pk_bf16_f32 v75, v78, v79
    v_cvt_pk_bf16_f32 v80, v80, v81
    v_cvt_pk_bf16_f32 v81, v82, v83
    ds_write_b128 v9, v[72:75] offset:25344
    ds_write_b64 v10, v[80:81] offset:25344
    s_add_u32 m0, s60, s31
    s_nop 0
    buffer_load_dwordx4 v1, s[4:7], s30 offen offset:0 nt lds
    buffer_load_dwordx4 v1, s[4:7], s30 offen offset:1024 nt lds
    buffer_load_dwordx4 v1, s[4:7], s30 offen offset:2048 nt lds
    buffer_load_dwordx4 v1, s[4:7], s30 offen offset:3072 nt lds
    s_add_u32 m0, m0, 4096
    s_add_u32 s55, s30, 4096
    s_mov_b64 exec, 0xffffffff
    buffer_load_dwordx4 v1, s[4:7], s55 offen nt lds
    s_mov_b64 exec, -1
    s_add_u32 s30, s30, s57
    s_add_u32 s31, s31, 19200
    s_add_u32 m0, s33, s62
    s_add_u32 s55, s32, s62
    buffer_load_dwordx4 v1, s[8:11], s55 offen nt lds
    s_add_u32 m0, s33, s63
    s_add_u32 s55, s32, s63
    s_mov_b64 exec, 0xff
    buffer_load_dwordx4 v1, s[8:11], s55 offen nt lds
    s_mov_b64 exec, -1
    s_add_u32 s32, s32, s58
    s_add_u32 s33, s33, 4608
    s_cmp_eq_u32 s33, 162240
    s_cselect_b32 s33, 134592, s33
    s_waitcnt vmcnt(22) lgkmcnt(0)
    s_barrier
    v_add_u32 v138, 0x12c00, v138
    v_add_u32 v139, 0x12c00, v139
    v_add_u32 v0, 0x12c00, v0
    v_add_u32 v2, 0x12c00, v2
    ds_read_b64_tr_b16 a[0:1], v138 offset:0
    ds_read_b64_tr_b16 a[2:3], v138 offset:768
    ds_read_b64_tr_b16 a[4:5], v138 offset:8
    ds_read_b64_tr_b16 a[6:7], v138 offset:776
    ds_read_b64_tr_b16 a[8:9], v0 offset:0
    ds_read_b64_tr_b16 a[10:11], v0 offset:768
    ds_read_b64_tr_b16 a[12:13], v139 offset:6144
    ds_read_b64_tr_b16 a[14:15], v139 offset:6912
    ds_read_b64_tr_b16 a[16:17], v139 offset:6152
    ds_read_b64_tr_b16 a[18:19], v139 offset:6920
    ds_read_b64_tr_b16 a[20:21], v2 offset:6144
    ds_read_b64_tr_b16 a[22:23], v2 offset:6912
    ds_read_b64_tr_b16 a[24:25], v138 offset:12672
    ds_read_b64_tr_b16 a[26:27], v138 offset:13440
    ds_read_b64_tr_b16 a[28:29], v138 offset:12680
    ds_read_b64_tr_b16 a[30:31], v138 offset:13448
    ds_read_b64_tr_b16 a[32:33], v0 offset:12672
    ds_read_b64_tr_b16 a[34:35], v0 offset:13440
    v_add_u32 v9, 38400, v9
    v_add_u32 v10, 38400, v10
    v_add_u32 v3, 38400, v3
    v_add_u32 v4, 9216, v4
    v_add_u32 v11, 9216, v11
    s_add_u32 s59, s26, 2
    s_add_u32 s36, s36, s57
    ds_read_b128 v[48:51], v6 offset:0
    ds_read_b128 v[52:55], v6 offset:3072
    ds_read_b128 v[56:59], v6 offset:6144
    ds_read_b128 v[60:63], v6 offset:64
    ds_read_b128 v[64:67], v6 offset:3136
    ds_read_b128 v[68:71], v6 offset:6208
    ds_read_b128 v[244:247], v6 offset:128
    ds_read_b128 v[248:251], v6 offset:3200
    s_waitcnt lgkmcnt(8)
    s_waitcnt lgkmcnt(7)
    v_mfma_f32_16x16x32_bf16 v[12:15], a[0:3], v[48:51], 0
    ds_read_b128 v[252:255], v6 offset:6272
    v_mfma_f32_16x16x32_bf16 v[16:19], a[4:7], v[48:51], 0
    v_mfma_f32_16x16x32_bf16 v[20:23], a[8:11], v[48:51], 0
    s_waitcnt vmcnt(17)
    s_barrier
    v_add_u32 v138, 0xffffb500, v138
    v_add_u32 v139, 0xffffb500, v139
    v_add_u32 v0, 0xffffb500, v0
    v_add_u32 v2, 0xffffb500, v2
    s_waitcnt lgkmcnt(7)
    v_mfma_f32_16x16x32_bf16 v[24:27], a[0:3], v[52:55], 0
    ds_read_b128 v[48:51], v7 offset:0
    s_add_u32 m0, s60, 115200
    s_add_u32 s55, s61, 73728
    v_mfma_f32_16x16x32_bf16 v[28:31], a[4:7], v[52:55], 0
    buffer_load_dwordx4 v1, s[16:19], s55 offen offset:0 lds
    buffer_load_dwordx4 v1, s[16:19], s55 offen offset:1024 lds
    buffer_load_dwordx4 v1, s[16:19], s55 offen offset:2048 lds
    v_mfma_f32_16x16x32_bf16 v[32:35], a[8:11], v[52:55], 0
    ds_read_b64_tr_b16 a[36:37], v138 offset:0
    ds_read_b64_tr_b16 a[38:39], v138 offset:768
    ds_read_b64_tr_b16 a[40:41], v138 offset:8
    s_waitcnt lgkmcnt(10)
    v_mfma_f32_16x16x32_bf16 v[36:39], a[0:3], v[56:59], 0
    ds_read_b128 v[52:55], v7 offset:3072
    buffer_load_dwordx4 v1, s[16:19], s55 offen offset:3072 lds
    s_add_u32 m0, m0, 4096
    v_mfma_f32_16x16x32_bf16 v[40:43], a[4:7], v[56:59], 0
    s_add_u32 s55, s55, 4096
    s_mov_b64 exec, 0xffffffff
    buffer_load_dwordx4 v1, s[16:19], s55 offen lds
    s_mov_b64 exec, -1
    ds_read_b64_tr_b16 a[42:43], v138 offset:776
    v_mfma_f32_16x16x32_bf16 v[44:47], a[8:11], v[56:59], 0
    ds_read_b64_tr_b16 a[44:45], v0 offset:0
    ds_read_b64_tr_b16 a[46:47], v0 offset:768
    s_waitcnt lgkmcnt(13)
    v_mfma_f32_16x16x32_bf16 v[12:15], a[12:15], v[60:63], v[12:15]
    ds_read_b128 v[56:59], v7 offset:6144
    ds_read_b64_tr_b16 a[48:49], v139 offset:6144
    v_mfma_f32_16x16x32_bf16 v[16:19], a[16:19], v[60:63], v[16:19]
    ds_read_b64_tr_b16 a[50:51], v139 offset:6912
    v_mfma_f32_16x16x32_bf16 v[20:23], a[20:23], v[60:63], v[20:23]
    ds_read_b64_tr_b16 a[52:53], v139 offset:6152
    s_waitcnt lgkmcnt(15)
    v_mfma_f32_16x16x32_bf16 v[24:27], a[12:15], v[64:67], v[24:27]
    ds_read_b128 v[60:63], v7 offset:64
    ds_read_b64_tr_b16 a[54:55], v139 offset:6920
    v_mfma_f32_16x16x32_bf16 v[28:31], a[16:19], v[64:67], v[28:31]
    ds_read_b64_tr_b16 a[56:57], v2 offset:6144
    v_mfma_f32_16x16x32_bf16 v[32:35], a[20:23], v[64:67], v[32:35]
    ds_read_b64_tr_b16 a[58:59], v2 offset:6912
    v_mfma_f32_16x16x32_bf16 v[36:39], a[12:15], v[68:71], v[36:39]
    ds_read_b128 v[64:67], v7 offset:3136
    ds_read_b64_tr_b16 a[60:61], v138 offset:12672
    v_mfma_f32_16x16x32_bf16 v[40:43], a[16:19], v[68:71], v[40:43]
    ds_read_b64_tr_b16 a[62:63], v138 offset:13440
    v_mfma_f32_16x16x32_bf16 v[44:47], a[20:23], v[68:71], v[44:47]
    ds_read_b64_tr_b16 a[64:65], v138 offset:12680
    s_waitcnt lgkmcnt(15)
    v_mfma_f32_16x16x32_bf16 v[12:15], a[24:27], v[244:247], v[12:15]
    ds_read_b128 v[68:71], v7 offset:6208
    ds_read_b64_tr_b16 a[66:67], v138 offset:13448
    v_mfma_f32_16x16x32_bf16 v[16:19], a[28:31], v[244:247], v[16:19]
    ds_read_b64_tr_b16 a[68:69], v0 offset:12672
    v_mfma_f32_16x16x32_bf16 v[20:23], a[32:35], v[244:247], v[20:23]
    ds_read_b64_tr_b16 a[70:71], v0 offset:13440
    v_mfma_f32_16x16x32_bf16 v[24:27], a[24:27], v[248:251], v[24:27]
    ds_read_b128 v[244:247], v7 offset:128
    v_mfma_f32_16x16x32_bf16 v[28:31], a[28:31], v[248:251], v[28:31]
    v_mfma_f32_16x16x32_bf16 v[32:35], a[32:35], v[248:251], v[32:35]
    v_mfma_f32_16x16x32_bf16 v[36:39], a[24:27], v[252:255], v[36:39]
    ds_read_b128 v[248:251], v7 offset:3200
    v_mfma_f32_16x16x32_bf16 v[40:43], a[28:31], v[252:255], v[40:43]
    v_mfma_f32_16x16x32_bf16 v[44:47], a[32:35], v[252:255], v[44:47]
    s_waitcnt lgkmcnt(2)
    v_mfma_f32_16x16x32_bf16 v[12:15], a[36:39], v[48:51], v[12:15]
    ds_read_b128 v[252:255], v7 offset:6272
    v_mfma_f32_16x16x32_bf16 v[16:19], a[40:43], v[48:51], v[16:19]
    v_mfma_f32_16x16x32_bf16 v[20:23], a[44:47], v[48:51], v[20:23]
    s_waitcnt vmcnt(17)
    s_barrier
    v_add_u32 v138, 0xffffb500, v138
    v_add_u32 v139, 0xffffb500, v139
    v_add_u32 v0, 0xffffb500, v0
    v_add_u32 v2, 0xffffb500, v2
    v_mfma_f32_16x16x32_bf16 v[24:27], a[36:39], v[52:55], v[24:27]
    ds_read_b128 v[48:51], v8 offset:0
    s_add_u32 m0, s60, 96000
    s_add_u32 s55, s61, 92160
    v_mfma_f32_16x16x32_bf16 v[28:31], a[40:43], v[52:55], v[28:31]
    buffer_load_dwordx4 v1, s[16:19], s55 offen offset:0 lds
    buffer_load_dwordx4 v1, s[16:19], s55 offen offset:1024 lds
    buffer_load_dwordx4 v1, s[16:19], s55 offen offset:2048 lds
    v_mfma_f32_16x16x32_bf16 v[32:35], a[44:47], v[52:55], v[32:35]
    ds_read_b64_tr_b16 a[72:73], v138 offset:0
    ds_read_b64_tr_b16 a[74:75], v138 offset:768
    ds_read_b64_tr_b16 a[76:77], v138 offset:8
    v_mfma_f32_16x16x32_bf16 v[36:39], a[36:39], v[56:59], v[36:39]
    ds_read_b128 v[52:55], v8 offset:3072
    buffer_load_dwordx4 v1, s[16:19], s55 offen offset:3072 lds
    s_add_u32 m0, m0, 4096
    v_mfma_f32_16x16x32_bf16 v[40:43], a[40:43], v[56:59], v[40:43]
    s_add_u32 s55, s55, 4096
    s_mov_b64 exec, 0xffffffff
    buffer_load_dwordx4 v1, s[16:19], s55 offen lds
    s_mov_b64 exec, -1
    ds_read_b64_tr_b16 a[78:79], v138 offset:776
    v_mfma_f32_16x16x32_bf16 v[44:47], a[44:47], v[56:59], v[44:47]
    ds_read_b64_tr_b16 a[80:81], v0 offset:0
    ds_read_b64_tr_b16 a[82:83], v0 offset:768
    v_mfma_f32_16x16x32_bf16 v[12:15], a[48:51], v[60:63], v[12:15]
    ds_read_b128 v[56:59], v8 offset:6144
    ds_read_b64_tr_b16 a[84:85], v139 offset:6144
    v_mfma_f32_16x16x32_bf16 v[16:19], a[52:55], v[60:63], v[16:19]
    ds_read_b64_tr_b16 a[86:87], v139 offset:6912
    v_mfma_f32_16x16x32_bf16 v[20:23], a[56:59], v[60:63], v[20:23]
    ds_read_b64_tr_b16 a[88:89], v139 offset:6152
    v_mfma_f32_16x16x32_bf16 v[24:27], a[48:51], v[64:67], v[24:27]
    ds_read_b128 v[60:63], v8 offset:64
    ds_read_b64_tr_b16 a[90:91], v139 offset:6920
    v_mfma_f32_16x16x32_bf16 v[28:31], a[52:55], v[64:67], v[28:31]
    ds_read_b64_tr_b16 a[92:93], v2 offset:6144
    v_mfma_f32_16x16x32_bf16 v[32:35], a[56:59], v[64:67], v[32:35]
    ds_read_b64_tr_b16 a[94:95], v2 offset:6912
    v_mfma_f32_16x16x32_bf16 v[36:39], a[48:51], v[68:71], v[36:39]
    ds_read_b128 v[64:67], v8 offset:3136
    ds_read_b64_tr_b16 a[96:97], v138 offset:12672
    v_mfma_f32_16x16x32_bf16 v[40:43], a[52:55], v[68:71], v[40:43]
    ds_read_b64_tr_b16 a[98:99], v138 offset:13440
    v_mfma_f32_16x16x32_bf16 v[44:47], a[56:59], v[68:71], v[44:47]
    ds_read_b64_tr_b16 a[100:101], v138 offset:12680
    s_waitcnt lgkmcnt(15)
    v_mfma_f32_16x16x32_bf16 v[12:15], a[60:63], v[244:247], v[12:15]
    ds_read_b128 v[68:71], v8 offset:6208
    ds_read_b64_tr_b16 a[102:103], v138 offset:13448
    v_mfma_f32_16x16x32_bf16 v[16:19], a[64:67], v[244:247], v[16:19]
    ds_read_b64_tr_b16 a[104:105], v0 offset:12672
    v_mfma_f32_16x16x32_bf16 v[20:23], a[68:71], v[244:247], v[20:23]
    ds_read_b64_tr_b16 a[106:107], v0 offset:13440
    v_mfma_f32_16x16x32_bf16 v[24:27], a[60:63], v[248:251], v[24:27]
    ds_read_b128 v[244:247], v8 offset:128
    v_mfma_f32_16x16x32_bf16 v[28:31], a[64:67], v[248:251], v[28:31]
    v_mfma_f32_16x16x32_bf16 v[32:35], a[68:71], v[248:251], v[32:35]
    v_mfma_f32_16x16x32_bf16 v[36:39], a[60:63], v[252:255], v[36:39]
    ds_read_b128 v[248:251], v8 offset:3200
    v_mfma_f32_16x16x32_bf16 v[40:43], a[64:67], v[252:255], v[40:43]
    v_mfma_f32_16x16x32_bf16 v[44:47], a[68:71], v[252:255], v[44:47]
    s_waitcnt lgkmcnt(2)
    v_mfma_f32_16x16x32_bf16 v[12:15], a[72:75], v[48:51], v[12:15]
    ds_read_b128 v[252:255], v8 offset:6272
    v_mfma_f32_16x16x32_bf16 v[16:19], a[76:79], v[48:51], v[16:19]
    v_mfma_f32_16x16x32_bf16 v[20:23], a[80:83], v[48:51], v[20:23]
    s_waitcnt vmcnt(17)
    s_barrier
    v_add_u32 v138, 0xffffb500, v138
    v_add_u32 v139, 0xffffb500, v139
    v_add_u32 v0, 0xffffb500, v0
    v_add_u32 v2, 0xffffb500, v2
    v_mfma_f32_16x16x32_bf16 v[24:27], a[72:75], v[52:55], v[24:27]
    ds_read_b128 v[48:51], v6 offset:9600
    s_add_u32 m0, s60, 76800
    s_add_u32 s55, s61, 110592
    v_mfma_f32_16x16x32_bf16 v[28:31], a[76:79], v[52:55], v[28:31]
    s_sub_u32 s55, s55, s56
    buffer_load_dwordx4 v1, s[16:19], s55 offen offset:0 lds
    buffer_load_dwordx4 v1, s[16:19], s55 offen offset:1024 lds
    v_mfma_f32_16x16x32_bf16 v[32:35], a[80:83], v[52:55], v[32:35]
    ds_read_b64_tr_b16 a[108:109], v138 offset:0
    ds_read_b64_tr_b16 a[110:111], v138 offset:768
    ds_read_b64_tr_b16 a[112:113], v138 offset:8
    v_mfma_f32_16x16x32_bf16 v[36:39], a[72:75], v[56:59], v[36:39]
    ds_read_b128 v[52:55], v6 offset:12672
    buffer_load_dwordx4 v1, s[16:19], s55 offen offset:2048 lds
    buffer_load_dwordx4 v1, s[16:19], s55 offen offset:3072 lds
    v_mfma_f32_16x16x32_bf16 v[40:43], a[76:79], v[56:59], v[40:43]
    s_add_u32 m0, m0, 4096
    s_add_u32 s55, s55, 4096
    s_mov_b64 exec, 0xffffffff
    buffer_load_dwordx4 v1, s[16:19], s55 offen lds
    s_mov_b64 exec, -1
    v_mfma_f32_16x16x32_bf16 v[44:47], a[80:83], v[56:59], v[44:47]
    ds_read_b64_tr_b16 a[114:115], v138 offset:776
    ds_read_b64_tr_b16 a[116:117], v0 offset:0
    ds_read_b64_tr_b16 a[118:119], v0 offset:768
    v_mfma_f32_16x16x32_bf16 v[12:15], a[84:87], v[60:63], v[12:15]
    ds_read_b128 v[56:59], v6 offset:15744
    ds_read_b64_tr_b16 a[120:121], v139 offset:6144
    v_mfma_f32_16x16x32_bf16 v[16:19], a[88:91], v[60:63], v[16:19]
    ds_read_b64_tr_b16 a[122:123], v139 offset:6912
    v_mfma_f32_16x16x32_bf16 v[20:23], a[92:95], v[60:63], v[20:23]
    ds_read_b64_tr_b16 a[124:125], v139 offset:6152
    v_mfma_f32_16x16x32_bf16 v[24:27], a[84:87], v[64:67], v[24:27]
    ds_read_b128 v[60:63], v6 offset:9664
    ds_read_b64_tr_b16 a[126:127], v139 offset:6920
    v_mfma_f32_16x16x32_bf16 v[28:31], a[88:91], v[64:67], v[28:31]
    ds_read_b64_tr_b16 a[128:129], v2 offset:6144
    v_mfma_f32_16x16x32_bf16 v[32:35], a[92:95], v[64:67], v[32:35]
    ds_read_b64_tr_b16 a[130:131], v2 offset:6912
    v_mfma_f32_16x16x32_bf16 v[36:39], a[84:87], v[68:71], v[36:39]
    ds_read_b128 v[64:67], v6 offset:12736
    ds_read_b64_tr_b16 a[132:133], v138 offset:12672
    v_mfma_f32_16x16x32_bf16 v[40:43], a[88:91], v[68:71], v[40:43]
    ds_read_b64_tr_b16 a[134:135], v138 offset:13440
    v_mfma_f32_16x16x32_bf16 v[44:47], a[92:95], v[68:71], v[44:47]
    ds_read_b64_tr_b16 a[136:137], v138 offset:12680
    s_waitcnt lgkmcnt(15)
    v_mfma_f32_16x16x32_bf16 v[12:15], a[96:99], v[244:247], v[12:15]
    ds_read_b128 v[68:71], v6 offset:15808
    ds_read_b64_tr_b16 a[138:139], v138 offset:13448
    v_mfma_f32_16x16x32_bf16 v[16:19], a[100:103], v[244:247], v[16:19]
    ds_read_b64_tr_b16 a[140:141], v0 offset:12672
    v_mfma_f32_16x16x32_bf16 v[20:23], a[104:107], v[244:247], v[20:23]
    ds_read_b64_tr_b16 a[142:143], v0 offset:13440
    v_mfma_f32_16x16x32_bf16 v[24:27], a[96:99], v[248:251], v[24:27]
    ds_read_b128 v[244:247], v6 offset:9728
    v_mfma_f32_16x16x32_bf16 v[28:31], a[100:103], v[248:251], v[28:31]
    v_mfma_f32_16x16x32_bf16 v[32:35], a[104:107], v[248:251], v[32:35]
    v_mfma_f32_16x16x32_bf16 v[36:39], a[96:99], v[252:255], v[36:39]
    ds_read_b128 v[248:251], v6 offset:12800
    v_mfma_f32_16x16x32_bf16 v[40:43], a[100:103], v[252:255], v[40:43]
    v_mfma_f32_16x16x32_bf16 v[44:47], a[104:107], v[252:255], v[44:47]
    s_waitcnt lgkmcnt(2)
    v_mfma_f32_16x16x32_bf16 v[12:15], a[108:111], v[48:51], v[12:15]
    ds_read_b128 v[252:255], v6 offset:15872
    v_mfma_f32_16x16x32_bf16 v[16:19], a[112:115], v[48:51], v[16:19]
    v_mfma_f32_16x16x32_bf16 v[20:23], a[116:119], v[48:51], v[20:23]
    s_waitcnt vmcnt(10)
    s_barrier
    v_add_u32 v138, 0xe100, v138
    v_add_u32 v139, 0xe100, v139
    v_add_u32 v0, 0xe100, v0
    v_add_u32 v2, 0xe100, v2
    v_mfma_f32_16x16x32_bf16 v[24:27], a[108:111], v[52:55], v[24:27]
    ds_read_b128 v[48:51], v7 offset:9600
    ds_read_b128 v[84:87], v3 offset:0
    v_mfma_f32_16x16x32_bf16 v[28:31], a[112:115], v[52:55], v[28:31]
    ds_read_b128 v[88:91], v3 offset:64
    ds_read_b64_tr_b16 a[144:145], v138 offset:0
    v_mfma_f32_16x16x32_bf16 v[32:35], a[116:119], v[52:55], v[32:35]
    ds_read_b64_tr_b16 a[146:147], v138 offset:768
    ds_read_b64_tr_b16 a[148:149], v138 offset:8
    v_mfma_f32_16x16x32_bf16 v[36:39], a[108:111], v[56:59], v[36:39]
    ds_read_b128 v[52:55], v7 offset:12672
    ds_read_b128 v[92:95], v3 offset:128
    v_mfma_f32_16x16x32_bf16 v[40:43], a[112:115], v[56:59], v[40:43]
    ds_read_b128 v[96:99], v3 offset:3072
    ds_read_b64_tr_b16 a[150:151], v138 offset:776
    v_mfma_f32_16x16x32_bf16 v[44:47], a[116:119], v[56:59], v[44:47]
    ds_read_b64_tr_b16 a[152:153], v0 offset:0
    ds_read_b64_tr_b16 a[154:155], v0 offset:768
    v_mfma_f32_16x16x32_bf16 v[12:15], a[120:123], v[60:63], v[12:15]
    ds_read_b128 v[56:59], v7 offset:15744
    ds_read_b128 v[100:103], v3 offset:3136
    v_mfma_f32_16x16x32_bf16 v[16:19], a[124:127], v[60:63], v[16:19]
    ds_read_b128 v[104:107], v3 offset:3200
    ds_read_b64_tr_b16 a[156:157], v139 offset:6144
    v_mfma_f32_16x16x32_bf16 v[20:23], a[128:131], v[60:63], v[20:23]
    ds_read_b64_tr_b16 a[158:159], v139 offset:6912
    ds_read_b64_tr_b16 a[160:161], v139 offset:6152
    v_mfma_f32_16x16x32_bf16 v[24:27], a[120:123], v[64:67], v[24:27]
    ds_read_b128 v[60:63], v7 offset:9664
    ds_read_b128 v[108:111], v3 offset:6144
    v_mfma_f32_16x16x32_bf16 v[28:31], a[124:127], v[64:67], v[28:31]
    ds_read_b128 v[112:115], v3 offset:6208
    ds_read_b64_tr_b16 a[162:163], v139 offset:6920
    v_mfma_f32_16x16x32_bf16 v[32:35], a[128:131], v[64:67], v[32:35]
    ds_read_b64_tr_b16 a[164:165], v2 offset:6144
    ds_read_b64_tr_b16 a[166:167], v2 offset:6912
    v_mfma_f32_16x16x32_bf16 v[36:39], a[120:123], v[68:71], v[36:39]
    ds_read_b128 v[64:67], v7 offset:12736
    ds_read_b128 v[116:119], v3 offset:6272
    v_mfma_f32_16x16x32_bf16 v[40:43], a[124:127], v[68:71], v[40:43]
    ds_read_b128 v[120:123], v4 offset:0
    ds_read_b64_tr_b16 a[168:169], v138 offset:12672
    v_mfma_f32_16x16x32_bf16 v[44:47], a[128:131], v[68:71], v[44:47]
    ds_read_b64_tr_b16 a[170:171], v138 offset:13440
    ds_read_b64_tr_b16 a[172:173], v138 offset:12680
    s_waitcnt lgkmcnt(15)
    v_mfma_f32_16x16x32_bf16 v[12:15], a[132:135], v[244:247], v[12:15]
    ds_read_b128 v[68:71], v7 offset:15808
    ds_read_b64 v[124:125], v11 offset:0
    v_mfma_f32_16x16x32_bf16 v[16:19], a[136:139], v[244:247], v[16:19]
    ds_read_b128 v[126:129], v4 offset:1536
    ds_read_b64_tr_b16 a[174:175], v138 offset:13448
    v_mfma_f32_16x16x32_bf16 v[20:23], a[140:143], v[244:247], v[20:23]
    ds_read_b64_tr_b16 a[176:177], v0 offset:12672
    ds_read_b64_tr_b16 a[178:179], v0 offset:13440
    v_mfma_f32_16x16x32_bf16 v[24:27], a[132:135], v[248:251], v[24:27]
    ds_read_b128 v[244:247], v7 offset:9728
    v_mfma_f32_16x16x32_bf16 v[28:31], a[136:139], v[248:251], v[28:31]
    ds_read_b64 v[130:131], v11 offset:1536
    v_mfma_f32_16x16x32_bf16 v[32:35], a[140:143], v[248:251], v[32:35]
    ds_read_b128 v[132:135], v4 offset:3072
    v_mfma_f32_16x16x32_bf16 v[36:39], a[132:135], v[252:255], v[36:39]
    ds_read_b128 v[248:251], v7 offset:12800
    v_mfma_f32_16x16x32_bf16 v[40:43], a[136:139], v[252:255], v[40:43]
    ds_read_b64 v[136:137], v11 offset:3072
    v_mfma_f32_16x16x32_bf16 v[44:47], a[140:143], v[252:255], v[44:47]
    s_waitcnt lgkmcnt(5)
    v_mfma_f32_16x16x32_bf16 v[12:15], a[144:147], v[48:51], v[12:15]
    ds_read_b128 v[252:255], v7 offset:15872
    v_mfma_f32_16x16x32_bf16 v[16:19], a[148:151], v[48:51], v[16:19]
    v_mfma_f32_16x16x32_bf16 v[20:23], a[152:155], v[48:51], v[20:23]
    s_waitcnt vmcnt(5)
    s_waitcnt lgkmcnt(1)
    s_barrier
    v_add_u32 v138, 0xffffb500, v138
    v_add_u32 v139, 0xffffb500, v139
    v_add_u32 v0, 0xffffb500, v0
    v_add_u32 v2, 0xffffb500, v2
    v_mfma_f32_16x16x32_bf16 v[24:27], a[144:147], v[52:55], v[24:27]
    ds_read_b128 v[48:51], v8 offset:9600
    s_add_u32 m0, s60, 115200
    s_add_u32 s55, s61, 129024
    v_mfma_f32_16x16x32_bf16 v[28:31], a[148:151], v[52:55], v[28:31]
    s_sub_u32 s55, s55, s56
    buffer_load_dwordx4 v1, s[16:19], s55 offen offset:0 lds
    buffer_load_dwordx4 v1, s[16:19], s55 offen offset:1024 lds
    v_mfma_f32_16x16x32_bf16 v[32:35], a[152:155], v[52:55], v[32:35]
    ds_read_b64_tr_b16 a[180:181], v138 offset:0
    ds_read_b64_tr_b16 a[182:183], v138 offset:768
    ds_read_b64_tr_b16 a[184:185], v138 offset:8
    v_mfma_f32_16x16x32_bf16 v[36:39], a[144:147], v[56:59], v[36:39]
    ds_read_b128 v[52:55], v8 offset:12672
    buffer_load_dwordx4 v1, s[16:19], s55 offen offset:2048 lds
    buffer_load_dwordx4 v1, s[16:19], s55 offen offset:3072 lds
    s_add_u32 m0, m0, 4096
    s_add_u32 s55, s55, 4096
    v_mfma_f32_16x16x32_bf16 v[40:43], a[148:151], v[56:59], v[40:43]
    s_mov_b64 exec, 0xffffffff
    buffer_load_dwordx4 v1, s[16:19], s55 offen lds
    s_mov_b64 exec, -1
    ds_read_b64_tr_b16 a[186:187], v138 offset:776
    ds_read_b64_tr_b16 a[188:189], v0 offset:0
    ds_read_b64_tr_b16 a[190:191], v0 offset:768
    v_lshlrev_b32 v72, 16, v120
    v_mfma_f32_16x16x32_bf16 v[44:47], a[152:155], v[56:59], v[44:47]
    v_and_b32 v73, 0xffff0000, v120
    v_lshlrev_b32 v74, 16, v121
    v_and_b32 v75, 0xffff0000, v121
    v_lshlrev_b32 v76, 16, v122
    v_and_b32 v77, 0xffff0000, v122
    v_mfma_f32_16x16x32_bf16 v[12:15], a[156:159], v[60:63], v[12:15]
    ds_read_b128 v[56:59], v8 offset:15744
    ds_read_b64_tr_b16 a[192:193], v139 offset:6144
    ds_read_b64_tr_b16 a[194:195], v139 offset:6912
    ds_read_b64_tr_b16 a[196:197], v139 offset:6152
    v_mfma_f32_16x16x32_bf16 v[16:19], a[160:163], v[60:63], v[16:19]
    v_lshlrev_b32 v78, 16, v123
    v_and_b32 v79, 0xffff0000, v123
    v_lshlrev_b32 v80, 16, v124
    v_mfma_f32_16x16x32_bf16 v[20:23], a[164:167], v[60:63], v[20:23]
    v_and_b32 v81, 0xffff0000, v124
    v_lshlrev_b32 v82, 16, v125
    v_and_b32 v83, 0xffff0000, v125
    v_mfma_f32_16x16x32_bf16 v[24:27], a[156:159], v[64:67], v[24:27]
    ds_read_b128 v[60:63], v8 offset:9664
    ds_read_b64_tr_b16 a[198:199], v139 offset:6920
    v_mfma_f32_16x16x32_bf16 v[28:31], a[160:163], v[64:67], v[28:31]
    ds_read_b64_tr_b16 a[200:201], v2 offset:6144
    v_mfma_f32_16x16x32_bf16 v[32:35], a[164:167], v[64:67], v[32:35]
    ds_read_b64_tr_b16 a[202:203], v2 offset:6912
    v_mfma_f32_16x16x32_bf16 v[72:75], v[140:143], v[84:87], v[72:75]
    v_mfma_f32_16x16x32_bf16 v[76:79], v[144:147], v[84:87], v[76:79]
    v_mfma_f32_16x16x32_bf16 v[36:39], a[156:159], v[68:71], v[36:39]
    ds_read_b128 v[64:67], v8 offset:12736
    ds_read_b64_tr_b16 a[204:205], v138 offset:12672
    v_mfma_f32_16x16x32_bf16 v[40:43], a[160:163], v[68:71], v[40:43]
    ds_read_b64_tr_b16 a[206:207], v138 offset:13440
    v_mfma_f32_16x16x32_bf16 v[44:47], a[164:167], v[68:71], v[44:47]
    ds_read_b64_tr_b16 a[208:209], v138 offset:12680
    v_mfma_f32_16x16x32_bf16 v[80:83], v[148:151], v[84:87], v[80:83]
    v_mfma_f32_16x16x32_bf16 v[72:75], v[152:155], v[88:91], v[72:75]
    v_mfma_f32_16x16x32_bf16 v[12:15], a[168:171], v[244:247], v[12:15]
    ds_read_b128 v[68:71], v8 offset:15808
    ds_read_b64_tr_b16 a[210:211], v138 offset:13448
    v_mfma_f32_16x16x32_bf16 v[16:19], a[172:175], v[244:247], v[16:19]
    ds_read_b64_tr_b16 a[212:213], v0 offset:12672
    v_mfma_f32_16x16x32_bf16 v[20:23], a[176:179], v[244:247], v[20:23]
    ds_read_b64_tr_b16 a[214:215], v0 offset:13440
    v_mfma_f32_16x16x32_bf16 v[76:79], v[156:159], v[88:91], v[76:79]
    v_mfma_f32_16x16x32_bf16 v[80:83], v[160:163], v[88:91], v[80:83]
    v_mfma_f32_16x16x32_bf16 v[24:27], a[168:171], v[248:251], v[24:27]
    ds_read_b128 v[244:247], v8 offset:9728
    v_mfma_f32_16x16x32_bf16 v[28:31], a[172:175], v[248:251], v[28:31]
    v_mfma_f32_16x16x32_bf16 v[32:35], a[176:179], v[248:251], v[32:35]
    v_mfma_f32_16x16x32_bf16 v[72:75], v[164:167], v[92:95], v[72:75]
    v_mfma_f32_16x16x32_bf16 v[76:79], v[168:171], v[92:95], v[76:79]
    s_waitcnt lgkmcnt(15)
    v_mfma_f32_16x16x32_bf16 v[36:39], a[168:171], v[252:255], v[36:39]
    ds_read_b128 v[248:251], v8 offset:12800
    v_mfma_f32_16x16x32_bf16 v[40:43], a[172:175], v[252:255], v[40:43]
    v_mfma_f32_16x16x32_bf16 v[44:47], a[176:179], v[252:255], v[44:47]
    v_mfma_f32_16x16x32_bf16 v[80:83], v[172:175], v[92:95], v[80:83]
    s_waitcnt lgkmcnt(2)
    v_mfma_f32_16x16x32_bf16 v[12:15], a[180:183], v[48:51], v[12:15]
    ds_read_b128 v[252:255], v8 offset:15872
    v_mfma_f32_16x16x32_bf16 v[16:19], a[184:187], v[48:51], v[16:19]
    v_mfma_f32_16x16x32_bf16 v[20:23], a[188:191], v[48:51], v[20:23]
    s_waitcnt vmcnt(5)
    s_barrier
    v_add_u32 v138, 0xffffb500, v138
    v_add_u32 v139, 0xffffb500, v139
    v_add_u32 v0, 0xffffb500, v0
    v_add_u32 v2, 0xffffb500, v2
    v_mfma_f32_16x16x32_bf16 v[24:27], a[180:183], v[52:55], v[24:27]
    ds_read_b128 v[48:51], v6 offset:19200
    s_add_u32 m0, s60, 96000
    s_add_u32 s55, s61, 147456
    v_mfma_f32_16x16x32_bf16 v[28:31], a[184:187], v[52:55], v[28:31]
    s_sub_u32 s55, s55, s56
    buffer_load_dwordx4 v1, s[16:19], s55 offen offset:0 lds
    buffer_load_dwordx4 v1, s[16:19], s55 offen offset:1024 lds
    v_mfma_f32_16x16x32_bf16 v[32:35], a[188:191], v[52:55], v[32:35]
    ds_read_b64_tr_b16 a[216:217], v138 offset:0
    ds_read_b64_tr_b16 a[218:219], v138 offset:768
    ds_read_b64_tr_b16 a[220:221], v138 offset:8
    v_mfma_f32_16x16x32_bf16 v[36:39], a[180:183], v[56:59], v[36:39]
    ds_read_b128 v[52:55], v6 offset:22272
    buffer_load_dwordx4 v1, s[16:19], s55 offen offset:2048 lds
    buffer_load_dwordx4 v1, s[16:19], s55 offen offset:3072 lds
    s_add_u32 m0, m0, 4096
    s_add_u32 s55, s55, 4096
    v_mfma_f32_16x16x32_bf16 v[40:43], a[184:187], v[56:59], v[40:43]
    s_mov_b64 exec, 0xffffffff
    buffer_load_dwordx4 v1, s[16:19], s55 offen lds
    s_mov_b64 exec, -1
    ds_read_b64_tr_b16 a[222:223], v138 offset:776
    ds_read_b64_tr_b16 a[224:225], v0 offset:0
    ds_read_b64_tr_b16 a[226:227], v0 offset:768
    v_mfma_f32_16x16x32_bf16 v[44:47], a[188:191], v[56:59], v[44:47]
    v_cvt_pk_bf16_f32 v72, v72, v73
    v_cvt_pk_bf16_f32 v73, v74, v75
    v_cvt_pk_bf16_f32 v74, v76, v77
    v_cvt_pk_bf16_f32 v75, v78, v79
    v_mfma_f32_16x16x32_bf16 v[12:15], a[192:195], v[60:63], v[12:15]
    ds_read_b128 v[56:59], v6 offset:25344
    s_add_u32 m0, s60, s31
    s_nop 0
    buffer_load_dwordx4 v1, s[4:7], s30 offen offset:0 nt lds
    v_mfma_f32_16x16x32_bf16 v[16:19], a[196:199], v[60:63], v[16:19]
    buffer_load_dwordx4 v1, s[4:7], s30 offen offset:1024 nt lds
    ds_read_b64_tr_b16 a[228:229], v139 offset:6144
    ds_read_b64_tr_b16 a[230:231], v139 offset:6912
    ds_read_b64_tr_b16 a[232:233], v139 offset:6152
    v_mfma_f32_16x16x32_bf16 v[20:23], a[200:203], v[60:63], v[20:23]
    ds_write_b128 v9, v[72:75] offset:0
    v_cvt_pk_bf16_f32 v80, v80, v81
    v_cvt_pk_bf16_f32 v81, v82, v83
    v_mfma_f32_16x16x32_bf16 v[24:27], a[192:195], v[64:67], v[24:27]
    ds_read_b128 v[60:63], v6 offset:19264
    buffer_load_dwordx4 v1, s[4:7], s30 offen offset:2048 nt lds
    buffer_load_dwordx4 v1, s[4:7], s30 offen offset:3072 nt lds
    s_add_u32 m0, m0, 4096
    v_mfma_f32_16x16x32_bf16 v[28:31], a[196:199], v[64:67], v[28:31]
    s_add_u32 s55, s30, 4096
    s_mov_b64 exec, 0xffffffff
    buffer_load_dwordx4 v1, s[4:7], s55 offen nt lds
    s_mov_b64 exec, -1
    ds_read_b64_tr_b16 a[234:235], v139 offset:6920
    v_mfma_f32_16x16x32_bf16 v[32:35], a[200:203], v[64:67], v[32:35]
    ds_read_b64_tr_b16 a[236:237], v2 offset:6144
    ds_read_b64_tr_b16 a[238:239], v2 offset:6912
    ds_write_b64 v10, v[80:81] offset:0
    v_mfma_f32_16x16x32_bf16 v[36:39], a[192:195], v[68:71], v[36:39]
    ds_read_b128 v[64:67], v6 offset:22336
    s_add_u32 s30, s30, s57
    s_add_u32 s31, s31, 19200
    ds_read_b64_tr_b16 a[240:241], v138 offset:12672
    v_mfma_f32_16x16x32_bf16 v[40:43], a[196:199], v[68:71], v[40:43]
    ds_read_b64_tr_b16 a[242:243], v138 offset:13440
    ds_read_b64_tr_b16 a[244:245], v138 offset:12680
    v_lshlrev_b32 v72, 16, v126
    v_and_b32 v73, 0xffff0000, v126
    v_mfma_f32_16x16x32_bf16 v[44:47], a[200:203], v[68:71], v[44:47]
    v_lshlrev_b32 v74, 16, v127
    v_and_b32 v75, 0xffff0000, v127
    v_lshlrev_b32 v76, 16, v128
    v_and_b32 v77, 0xffff0000, v128
    s_waitcnt lgkmcnt(15)
    v_mfma_f32_16x16x32_bf16 v[12:15], a[204:207], v[244:247], v[12:15]
    ds_read_b128 v[68:71], v6 offset:25408
    s_add_u32 m0, s33, s62
    s_add_u32 s55, s32, s62
    buffer_load_dwordx4 v1, s[8:11], s55 offen nt lds
    ds_read_b64_tr_b16 a[246:247], v138 offset:13448
    v_mfma_f32_16x16x32_bf16 v[16:19], a[208:211], v[244:247], v[16:19]
    ds_read_b64_tr_b16 a[248:249], v0 offset:12672
    ds_read_b64_tr_b16 a[250:251], v0 offset:13440
    v_lshlrev_b32 v78, 16, v129
    v_and_b32 v79, 0xffff0000, v129
    v_mfma_f32_16x16x32_bf16 v[20:23], a[212:215], v[244:247], v[20:23]
    v_lshlrev_b32 v80, 16, v130
    v_and_b32 v81, 0xffff0000, v130
    v_lshlrev_b32 v82, 16, v131
    v_and_b32 v83, 0xffff0000, v131
    v_mfma_f32_16x16x32_bf16 v[24:27], a[204:207], v[248:251], v[24:27]
    ds_read_b128 v[244:247], v6 offset:19328
    s_add_u32 m0, s33, s63
    v_mfma_f32_16x16x32_bf16 v[28:31], a[208:211], v[248:251], v[28:31]
    s_add_u32 s55, s32, s63
    v_mfma_f32_16x16x32_bf16 v[32:35], a[212:215], v[248:251], v[32:35]
    s_mov_b64 exec, 0xff
    buffer_load_dwordx4 v1, s[8:11], s55 offen nt lds
    s_mov_b64 exec, -1
    v_mfma_f32_16x16x32_bf16 v[72:75], v[140:143], v[96:99], v[72:75]
    v_mfma_f32_16x16x32_bf16 v[76:79], v[144:147], v[96:99], v[76:79]
    v_mfma_f32_16x16x32_bf16 v[36:39], a[204:207], v[252:255], v[36:39]
    ds_read_b128 v[248:251], v6 offset:22400
    s_add_u32 s32, s32, s58
    v_mfma_f32_16x16x32_bf16 v[40:43], a[208:211], v[252:255], v[40:43]
    s_add_u32 s33, s33, 4608
    s_cmp_eq_u32 s33, 162240
    v_mfma_f32_16x16x32_bf16 v[44:47], a[212:215], v[252:255], v[44:47]
    s_cselect_b32 s33, 134592, s33
    v_mfma_f32_16x16x32_bf16 v[80:83], v[148:151], v[96:99], v[80:83]
    v_mfma_f32_16x16x32_bf16 v[72:75], v[152:155], v[100:103], v[72:75]
    s_waitcnt lgkmcnt(2)
    v_mfma_f32_16x16x32_bf16 v[12:15], a[216:219], v[48:51], v[12:15]
    ds_read_b128 v[252:255], v6 offset:25472
    v_mfma_f32_16x16x32_bf16 v[16:19], a[220:223], v[48:51], v[16:19]
    v_mfma_f32_16x16x32_bf16 v[20:23], a[224:227], v[48:51], v[20:23]
    v_mfma_f32_16x16x32_bf16 v[76:79], v[156:159], v[100:103], v[76:79]
    v_mfma_f32_16x16x32_bf16 v[80:83], v[160:163], v[100:103], v[80:83]
    s_waitcnt vmcnt(12)
    s_barrier
    v_add_u32 v138, 0x9600, v138
    v_add_u32 v139, 0x9600, v139
    v_add_u32 v0, 0x9600, v0
    v_add_u32 v2, 0x9600, v2
    v_mfma_f32_16x16x32_bf16 v[24:27], a[216:219], v[52:55], v[24:27]
    ds_read_b128 v[48:51], v7 offset:19200
    ds_read_b64_tr_b16 a[252:253], v138 offset:0
    v_mfma_f32_16x16x32_bf16 v[28:31], a[220:223], v[52:55], v[28:31]
    ds_read_b64_tr_b16 a[254:255], v138 offset:768
    v_mfma_f32_16x16x32_bf16 v[32:35], a[224:227], v[52:55], v[32:35]
    ds_read_b64_tr_b16 v[176:177], v138 offset:8
    v_mfma_f32_16x16x32_bf16 v[72:75], v[164:167], v[104:107], v[72:75]
    v_mfma_f32_16x16x32_bf16 v[76:79], v[168:171], v[104:107], v[76:79]
    v_mfma_f32_16x16x32_bf16 v[36:39], a[216:219], v[56:59], v[36:39]
    ds_read_b128 v[52:55], v7 offset:22272
    ds_read_b64_tr_b16 v[178:179], v138 offset:776
    v_mfma_f32_16x16x32_bf16 v[40:43], a[220:223], v[56:59], v[40:43]
    ds_read_b64_tr_b16 v[180:181], v0 offset:0
    v_mfma_f32_16x16x32_bf16 v[44:47], a[224:227], v[56:59], v[44:47]
    ds_read_b64_tr_b16 v[182:183], v0 offset:768
    v_mfma_f32_16x16x32_bf16 v[80:83], v[172:175], v[104:107], v[80:83]
    v_mfma_f32_16x16x32_bf16 v[12:15], a[228:231], v[60:63], v[12:15]
    ds_read_b128 v[56:59], v7 offset:25344
    ds_read_b64_tr_b16 v[184:185], v139 offset:6144
    v_mfma_f32_16x16x32_bf16 v[16:19], a[232:235], v[60:63], v[16:19]
    ds_read_b64_tr_b16 v[186:187], v139 offset:6912
    v_mfma_f32_16x16x32_bf16 v[20:23], a[236:239], v[60:63], v[20:23]
    ds_read_b64_tr_b16 v[188:189], v139 offset:6152
    v_mfma_f32_16x16x32_bf16 v[24:27], a[228:231], v[64:67], v[24:27]
    ds_read_b128 v[60:63], v7 offset:19264
    ds_read_b64_tr_b16 v[190:191], v139 offset:6920
    v_mfma_f32_16x16x32_bf16 v[28:31], a[232:235], v[64:67], v[28:31]
    ds_read_b64_tr_b16 v[192:193], v2 offset:6144
    v_mfma_f32_16x16x32_bf16 v[32:35], a[236:239], v[64:67], v[32:35]
    ds_read_b64_tr_b16 v[194:195], v2 offset:6912
    v_mfma_f32_16x16x32_bf16 v[36:39], a[228:231], v[68:71], v[36:39]
    ds_read_b128 v[64:67], v7 offset:22336
    ds_read_b64_tr_b16 v[196:197], v138 offset:12672
    ds_read_b64_tr_b16 v[198:199], v138 offset:13440
    v_mfma_f32_16x16x32_bf16 v[40:43], a[232:235], v[68:71], v[40:43]
    ds_read_b64_tr_b16 v[200:201], v138 offset:12680
    v_cvt_pk_bf16_f32 v72, v72, v73
    v_cvt_pk_bf16_f32 v73, v74, v75
    v_mfma_f32_16x16x32_bf16 v[44:47], a[236:239], v[68:71], v[44:47]
    v_cvt_pk_bf16_f32 v74, v76, v77
    v_cvt_pk_bf16_f32 v75, v78, v79
    s_waitcnt lgkmcnt(15)
    v_mfma_f32_16x16x32_bf16 v[12:15], a[240:243], v[244:247], v[12:15]
    ds_read_b128 v[68:71], v7 offset:25408
    ds_read_b64_tr_b16 v[202:203], v138 offset:13448
    ds_read_b64_tr_b16 v[204:205], v0 offset:12672
    v_mfma_f32_16x16x32_bf16 v[16:19], a[244:247], v[244:247], v[16:19]
    ds_read_b64_tr_b16 v[206:207], v0 offset:13440
    ds_write_b128 v9, v[72:75] offset:3072
    v_mfma_f32_16x16x32_bf16 v[20:23], a[248:251], v[244:247], v[20:23]
    v_cvt_pk_bf16_f32 v80, v80, v81
    v_cvt_pk_bf16_f32 v81, v82, v83
    v_mfma_f32_16x16x32_bf16 v[24:27], a[240:243], v[248:251], v[24:27]
    ds_read_b128 v[244:247], v7 offset:19328
    v_mfma_f32_16x16x32_bf16 v[28:31], a[244:247], v[248:251], v[28:31]
    ds_write_b64 v10, v[80:81] offset:3072
    v_mfma_f32_16x16x32_bf16 v[32:35], a[248:251], v[248:251], v[32:35]
    v_mfma_f32_16x16x32_bf16 v[36:39], a[240:243], v[252:255], v[36:39]
    ds_read_b128 v[248:251], v7 offset:22400
    v_lshlrev_b32 v72, 16, v132
    v_and_b32 v73, 0xffff0000, v132
    v_mfma_f32_16x16x32_bf16 v[40:43], a[244:247], v[252:255], v[40:43]
    v_lshlrev_b32 v74, 16, v133
    v_and_b32 v75, 0xffff0000, v133
    v_mfma_f32_16x16x32_bf16 v[44:47], a[248:251], v[252:255], v[44:47]
    v_lshlrev_b32 v76, 16, v134
    v_and_b32 v77, 0xffff0000, v134
    s_waitcnt lgkmcnt(4)
    v_mfma_f32_16x16x32_bf16 v[12:15], a[252:255], v[48:51], v[12:15]
    ds_read_b128 v[252:255], v7 offset:25472
    v_lshlrev_b32 v78, 16, v135
    v_and_b32 v79, 0xffff0000, v135
    v_mfma_f32_16x16x32_bf16 v[16:19], v[176:179], v[48:51], v[16:19]
    v_lshlrev_b32 v80, 16, v136
    v_and_b32 v81, 0xffff0000, v136
    v_mfma_f32_16x16x32_bf16 v[20:23], v[180:183], v[48:51], v[20:23]
    v_lshlrev_b32 v82, 16, v137
    v_and_b32 v83, 0xffff0000, v137
    s_waitcnt vmcnt(7)
    s_barrier
    v_add_u32 v138, 0xffffb500, v138
    v_add_u32 v139, 0xffffb500, v139
    v_add_u32 v0, 0xffffb500, v0
    v_add_u32 v2, 0xffffb500, v2
    v_mfma_f32_16x16x32_bf16 v[24:27], a[252:255], v[52:55], v[24:27]
    ds_read_b128 v[48:51], v8 offset:19200
    ds_read_b64_tr_b16 v[208:209], v138 offset:0
    v_mfma_f32_16x16x32_bf16 v[28:31], v[176:179], v[52:55], v[28:31]
    ds_read_b64_tr_b16 v[210:211], v138 offset:768
    v_mfma_f32_16x16x32_bf16 v[32:35], v[180:183], v[52:55], v[32:35]
    ds_read_b64_tr_b16 v[212:213], v138 offset:8
    v_mfma_f32_16x16x32_bf16 v[72:75], v[140:143], v[108:111], v[72:75]
    v_mfma_f32_16x16x32_bf16 v[76:79], v[144:147], v[108:111], v[76:79]
    v_mfma_f32_16x16x32_bf16 v[36:39], a[252:255], v[56:59], v[36:39]
    ds_read_b128 v[52:55], v8 offset:22272
    ds_read_b64_tr_b16 v[214:215], v138 offset:776
    v_mfma_f32_16x16x32_bf16 v[40:43], v[176:179], v[56:59], v[40:43]
    ds_read_b64_tr_b16 v[216:217], v0 offset:0
    v_mfma_f32_16x16x32_bf16 v[44:47], v[180:183], v[56:59], v[44:47]
    ds_read_b64_tr_b16 v[218:219], v0 offset:768
    v_mfma_f32_16x16x32_bf16 v[80:83], v[148:151], v[108:111], v[80:83]
    v_mfma_f32_16x16x32_bf16 v[72:75], v[152:155], v[112:115], v[72:75]
    v_mfma_f32_16x16x32_bf16 v[12:15], v[184:187], v[60:63], v[12:15]
    ds_read_b128 v[56:59], v8 offset:25344
    s_add_u32 m0, s60, s31
    s_nop 0
    v_mfma_f32_16x16x32_bf16 v[16:19], v[188:191], v[60:63], v[16:19]
    buffer_load_dwordx4 v1, s[4:7], s30 offen offset:0 nt lds
    buffer_load_dwordx4 v1, s[4:7], s30 offen offset:1024 nt lds
    ds_read_b64_tr_b16 v[220:221], v139 offset:6144
    v_mfma_f32_16x16x32_bf16 v[20:23], v[192:195], v[60:63], v[20:23]
    ds_read_b64_tr_b16 v[222:223], v139 offset:6912
    ds_read_b64_tr_b16 v[224:225], v139 offset:6152
    v_mfma_f32_16x16x32_bf16 v[76:79], v[156:159], v[112:115], v[76:79]
    v_mfma_f32_16x16x32_bf16 v[80:83], v[160:163], v[112:115], v[80:83]
    v_mfma_f32_16x16x32_bf16 v[24:27], v[184:187], v[64:67], v[24:27]
    ds_read_b128 v[60:63], v8 offset:19264
    buffer_load_dwordx4 v1, s[4:7], s30 offen offset:2048 nt lds
    buffer_load_dwordx4 v1, s[4:7], s30 offen offset:3072 nt lds
    v_mfma_f32_16x16x32_bf16 v[28:31], v[188:191], v[64:67], v[28:31]
    s_add_u32 m0, m0, 4096
    s_add_u32 s55, s30, 4096
    s_mov_b64 exec, 0xffffffff
    buffer_load_dwordx4 v1, s[4:7], s55 offen nt lds
    s_mov_b64 exec, -1
    v_mfma_f32_16x16x32_bf16 v[32:35], v[192:195], v[64:67], v[32:35]
    ds_read_b64_tr_b16 v[226:227], v139 offset:6920
    ds_read_b64_tr_b16 v[228:229], v2 offset:6144
    ds_read_b64_tr_b16 v[230:231], v2 offset:6912
    v_mfma_f32_16x16x32_bf16 v[72:75], v[164:167], v[116:119], v[72:75]
    v_mfma_f32_16x16x32_bf16 v[76:79], v[168:171], v[116:119], v[76:79]
    v_mfma_f32_16x16x32_bf16 v[36:39], v[184:187], v[68:71], v[36:39]
    ds_read_b128 v[64:67], v8 offset:22336
    s_add_u32 s30, s30, s57
    v_mfma_f32_16x16x32_bf16 v[40:43], v[188:191], v[68:71], v[40:43]
    s_add_u32 s31, s31, 19200
    ds_read_b64_tr_b16 v[232:233], v138 offset:12672
    v_mfma_f32_16x16x32_bf16 v[44:47], v[192:195], v[68:71], v[44:47]
    ds_read_b64_tr_b16 v[234:235], v138 offset:13440
    ds_read_b64_tr_b16 v[236:237], v138 offset:12680
    v_mfma_f32_16x16x32_bf16 v[80:83], v[172:175], v[116:119], v[80:83]
    s_waitcnt lgkmcnt(15)
    v_mfma_f32_16x16x32_bf16 v[12:15], v[196:199], v[244:247], v[12:15]
    ds_read_b128 v[68:71], v8 offset:25408
    s_add_u32 m0, s33, s62
    s_add_u32 s55, s32, s62
    v_mfma_f32_16x16x32_bf16 v[16:19], v[200:203], v[244:247], v[16:19]
    buffer_load_dwordx4 v1, s[8:11], s55 offen nt lds
    ds_read_b64_tr_b16 v[238:239], v138 offset:13448
    v_mfma_f32_16x16x32_bf16 v[20:23], v[204:207], v[244:247], v[20:23]
    ds_read_b64_tr_b16 v[240:241], v0 offset:12672
    ds_read_b64_tr_b16 v[242:243], v0 offset:13440
    v_mfma_f32_16x16x32_bf16 v[24:27], v[196:199], v[248:251], v[24:27]
    ds_read_b128 v[244:247], v8 offset:19328
    s_add_u32 m0, s33, s63
    v_mfma_f32_16x16x32_bf16 v[28:31], v[200:203], v[248:251], v[28:31]
    s_add_u32 s55, s32, s63
    v_mfma_f32_16x16x32_bf16 v[32:35], v[204:207], v[248:251], v[32:35]
    s_mov_b64 exec, 0xff
    buffer_load_dwordx4 v1, s[8:11], s55 offen nt lds
    s_mov_b64 exec, -1
    v_mfma_f32_16x16x32_bf16 v[36:39], v[196:199], v[252:255], v[36:39]
    ds_read_b128 v[248:251], v8 offset:22400
    s_add_u32 s32, s32, s58
    s_add_u32 s33, s33, 4608
    v_mfma_f32_16x16x32_bf16 v[40:43], v[200:203], v[252:255], v[40:43]
    s_cmp_eq_u32 s33, 162240
    s_cselect_b32 s33, 134592, s33
    v_cvt_pk_bf16_f32 v72, v72, v73
    v_mfma_f32_16x16x32_bf16 v[44:47], v[204:207], v[252:255], v[44:47]
    v_cvt_pk_bf16_f32 v73, v74, v75
    v_cvt_pk_bf16_f32 v74, v76, v77
    v_cvt_pk_bf16_f32 v75, v78, v79
    s_waitcnt lgkmcnt(2)
    v_mfma_f32_16x16x32_bf16 v[12:15], v[208:211], v[48:51], v[12:15]
    ds_read_b128 v[252:255], v8 offset:25472
    ds_write_b128 v9, v[72:75] offset:6144
    v_mfma_f32_16x16x32_bf16 v[16:19], v[212:215], v[48:51], v[16:19]
    v_cvt_pk_bf16_f32 v80, v80, v81
    v_mfma_f32_16x16x32_bf16 v[20:23], v[216:219], v[48:51], v[20:23]
    v_cvt_pk_bf16_f32 v81, v82, v83
    v_mfma_f32_16x16x32_bf16 v[24:27], v[208:211], v[52:55], v[24:27]
    ds_read_b128 v[48:51], v6 offset:19200
    v_mfma_f32_16x16x32_bf16 v[28:31], v[212:215], v[52:55], v[28:31]
    ds_write_b64 v10, v[80:81] offset:6144
    v_mfma_f32_16x16x32_bf16 v[32:35], v[216:219], v[52:55], v[32:35]
    v_mfma_f32_16x16x32_bf16 v[36:39], v[208:211], v[56:59], v[36:39]
    ds_read_b128 v[52:55], v6 offset:19264
    v_mfma_f32_16x16x32_bf16 v[40:43], v[212:215], v[56:59], v[40:43]
    v_mfma_f32_16x16x32_bf16 v[44:47], v[216:219], v[56:59], v[44:47]
    v_mfma_f32_16x16x32_bf16 v[12:15], v[220:223], v[60:63], v[12:15]
    ds_read_b128 v[56:59], v6 offset:19328
    v_mfma_f32_16x16x32_bf16 v[16:19], v[224:227], v[60:63], v[16:19]
    v_mfma_f32_16x16x32_bf16 v[20:23], v[228:231], v[60:63], v[20:23]
    v_mfma_f32_16x16x32_bf16 v[24:27], v[220:223], v[64:67], v[24:27]
    ds_read_b128 v[60:63], v7 offset:19200
    s_mov_b32 s53, 4608
    v_mfma_f32_16x16x32_bf16 v[28:31], v[224:227], v[64:67], v[28:31]
    s_add_u32 s59, s59, 1
    s_cmp_eq_u32 s59, 6
    v_mfma_f32_16x16x32_bf16 v[32:35], v[228:231], v[64:67], v[32:35]
    s_cselect_b32 s53, 0xffffa600, s53
    v_mfma_f32_16x16x32_bf16 v[36:39], v[220:223], v[68:71], v[36:39]
    ds_read_b128 v[64:67], v7 offset:19264
    v_mfma_f32_16x16x32_bf16 v[40:43], v[224:227], v[68:71], v[40:43]
    v_mfma_f32_16x16x32_bf16 v[44:47], v[228:231], v[68:71], v[44:47]
    s_waitcnt lgkmcnt(9)
    v_mfma_f32_16x16x32_bf16 v[12:15], v[232:235], v[244:247], v[12:15]
    ds_read_b128 v[68:71], v7 offset:19328
    v_mfma_f32_16x16x32_bf16 v[16:19], v[236:239], v[244:247], v[16:19]
    v_add_u32 v4, s53, v4
    v_mfma_f32_16x16x32_bf16 v[20:23], v[240:243], v[244:247], v[20:23]
    v_add_u32 v11, s53, v11
    s_waitcnt lgkmcnt(9)
    v_mfma_f32_16x16x32_bf16 v[24:27], v[232:235], v[248:251], v[24:27]
    ds_read_b128 v[244:247], v8 offset:19200
    v_mfma_f32_16x16x32_bf16 v[28:31], v[236:239], v[248:251], v[28:31]
    v_mfma_f32_16x16x32_bf16 v[32:35], v[240:243], v[248:251], v[32:35]
    s_waitcnt lgkmcnt(9)
    v_mfma_f32_16x16x32_bf16 v[36:39], v[232:235], v[252:255], v[36:39]
    ds_read_b128 v[248:251], v8 offset:19264
    v_mfma_f32_16x16x32_bf16 v[40:43], v[236:239], v[252:255], v[40:43]
    v_mfma_f32_16x16x32_bf16 v[44:47], v[240:243], v[252:255], v[44:47]
    v_add_u32 v9, 19200, v9
    v_add_u32 v10, 19200, v10
    v_add_u32 v3, 19200, v3
    v_add_u32 v6, 19200, v6
    v_add_u32 v7, 19200, v7
    v_add_u32 v8, 19200, v8
    v_sub_u32 v138, v11, v4
    v_add_u32 v2, v5, v138
    v_cvt_pk_bf16_f32 v12, v12, v13
    v_cvt_pk_bf16_f32 v13, v14, v15
    v_cvt_pk_bf16_f32 v14, v16, v17
    v_cvt_pk_bf16_f32 v15, v18, v19
    buffer_store_dwordx4 v[12:15], v5, s[20:23], s34 offen
    v_cvt_pk_bf16_f32 v20, v20, v21
    v_cvt_pk_bf16_f32 v21, v22, v23
    buffer_store_dwordx2 v[20:21], v2, s[20:23], s34 offen
    s_add_u32 s34, s34, s57
    v_cvt_pk_bf16_f32 v24, v24, v25
    v_cvt_pk_bf16_f32 v25, v26, v27
    v_cvt_pk_bf16_f32 v26, v28, v29
    v_cvt_pk_bf16_f32 v27, v30, v31
    buffer_store_dwordx4 v[24:27], v5, s[20:23], s35 offen
    v_cvt_pk_bf16_f32 v32, v32, v33
    v_cvt_pk_bf16_f32 v33, v34, v35
    buffer_store_dwordx2 v[32:33], v2, s[20:23], s35 offen
    s_add_u32 s35, s35, s57
    s_mov_b32 s37, 0
L_loop:
    s_waitcnt lgkmcnt(7)
    v_mfma_f32_16x16x32_bf16 v[12:15], a[0:3], v[48:51], 0
    ds_read_b128 v[252:255], v8 offset:128
    v_mfma_f32_16x16x32_bf16 v[16:19], a[4:7], v[48:51], 0
    v_mfma_f32_16x16x32_bf16 v[20:23], a[8:11], v[48:51], 0
    s_waitcnt lgkmcnt(7)
    v_mfma_f32_16x16x32_bf16 v[12:15], a[12:15], v[52:55], v[12:15]
    s_waitcnt vmcnt(11)
    s_barrier
    ds_read_b128 v[48:51], v6 offset:9600
    v_mfma_f32_16x16x32_bf16 v[16:19], a[16:19], v[52:55], v[16:19]
    v_mfma_f32_16x16x32_bf16 v[20:23], a[20:23], v[52:55], v[20:23]
    s_waitcnt lgkmcnt(7)
    v_mfma_f32_16x16x32_bf16 v[12:15], a[24:27], v[56:59], v[12:15]
    ds_read_b128 v[52:55], v6 offset:9664
    v_mfma_f32_16x16x32_bf16 v[16:19], a[28:31], v[56:59], v[16:19]
    ds_read_b128 v[120:123], v4 offset:0
    v_mfma_f32_16x16x32_bf16 v[20:23], a[32:35], v[56:59], v[20:23]
    s_waitcnt lgkmcnt(8)
    v_mfma_f32_16x16x32_bf16 v[12:15], a[36:39], v[60:63], v[12:15]
    ds_read_b128 v[56:59], v6 offset:9728
    v_cvt_pk_bf16_f32 v36, v36, v37
    v_mfma_f32_16x16x32_bf16 v[16:19], a[40:43], v[60:63], v[16:19]
    v_cvt_pk_bf16_f32 v37, v38, v39
    v_mfma_f32_16x16x32_bf16 v[20:23], a[44:47], v[60:63], v[20:23]
    ds_read_b64 v[124:125], v11 offset:0
    s_waitcnt lgkmcnt(9)
    v_mfma_f32_16x16x32_bf16 v[12:15], a[48:51], v[64:67], v[12:15]
    ds_read_b128 v[60:63], v7 offset:9600
    v_cvt_pk_bf16_f32 v38, v40, v41
    v_mfma_f32_16x16x32_bf16 v[16:19], a[52:55], v[64:67], v[16:19]
    v_cvt_pk_bf16_f32 v39, v42, v43
    v_mfma_f32_16x16x32_bf16 v[20:23], a[56:59], v[64:67], v[20:23]
    ds_read_b128 v[84:87], v3 offset:0
    s_waitcnt lgkmcnt(10)
    v_mfma_f32_16x16x32_bf16 v[12:15], a[60:63], v[68:71], v[12:15]
    ds_read_b128 v[64:67], v7 offset:9664
    v_mfma_f32_16x16x32_bf16 v[16:19], a[64:67], v[68:71], v[16:19]
    buffer_store_dwordx4 v[36:39], v5, s[20:23], s36 offen
    v_mfma_f32_16x16x32_bf16 v[20:23], a[68:71], v[68:71], v[20:23]
    ds_read_b128 v[88:91], v3 offset:64
    s_waitcnt lgkmcnt(11)
    v_mfma_f32_16x16x32_bf16 v[12:15], a[72:75], v[244:247], v[12:15]
    ds_read_b128 v[68:71], v7 offset:9728
    v_mfma_f32_16x16x32_bf16 v[16:19], a[76:79], v[244:247], v[16:19]
    ds_read_b128 v[92:95], v3 offset:128
    v_mfma_f32_16x16x32_bf16 v[20:23], a[80:83], v[244:247], v[20:23]
    s_waitcnt lgkmcnt(12)
    v_mfma_f32_16x16x32_bf16 v[12:15], a[84:87], v[248:251], v[12:15]
    ds_read_b128 v[244:247], v8 offset:9600
    v_cvt_pk_bf16_f32 v44, v44, v45
    v_mfma_f32_16x16x32_bf16 v[16:19], a[88:91], v[248:251], v[16:19]
    v_cvt_pk_bf16_f32 v45, v46, v47
    v_mfma_f32_16x16x32_bf16 v[20:23], a[92:95], v[248:251], v[20:23]
    ds_read_b128 v[126:129], v4 offset:1536
    s_waitcnt lgkmcnt(13)
    v_mfma_f32_16x16x32_bf16 v[12:15], a[96:99], v[252:255], v[12:15]
    ds_read_b128 v[248:251], v8 offset:9664
    v_mfma_f32_16x16x32_bf16 v[16:19], a[100:103], v[252:255], v[16:19]
    buffer_store_dwordx2 v[44:45], v2, s[20:23], s36 offen
    v_mfma_f32_16x16x32_bf16 v[20:23], a[104:107], v[252:255], v[20:23]
    ds_read_b64 v[130:131], v11 offset:1536
    s_waitcnt lgkmcnt(14)
    v_mfma_f32_16x16x32_bf16 v[12:15], a[108:111], v[48:51], v[12:15]
    ds_read_b128 v[252:255], v8 offset:9728
    v_mfma_f32_16x16x32_bf16 v[16:19], a[112:115], v[48:51], v[16:19]
    s_add_u32 s36, s36, s57
    v_mfma_f32_16x16x32_bf16 v[20:23], a[116:119], v[48:51], v[20:23]
    ds_read_b128 v[96:99], v3 offset:3072
    s_waitcnt lgkmcnt(15)
    v_mfma_f32_16x16x32_bf16 v[12:15], a[120:123], v[52:55], v[12:15]
    ds_read_b128 v[48:51], v6 offset:19200
    v_mfma_f32_16x16x32_bf16 v[16:19], a[124:127], v[52:55], v[16:19]
    ds_read_b128 v[100:103], v3 offset:3136
    v_mfma_f32_16x16x32_bf16 v[20:23], a[128:131], v[52:55], v[20:23]
    s_waitcnt lgkmcnt(15)
    v_mfma_f32_16x16x32_bf16 v[12:15], a[132:135], v[56:59], v[12:15]
    ds_read_b128 v[52:55], v6 offset:19264
    v_mfma_f32_16x16x32_bf16 v[16:19], a[136:139], v[56:59], v[16:19]
    ds_read_b128 v[104:107], v3 offset:3200
    v_mfma_f32_16x16x32_bf16 v[20:23], a[140:143], v[56:59], v[20:23]
    s_waitcnt lgkmcnt(10)
    v_mfma_f32_16x16x32_bf16 v[12:15], a[144:147], v[60:63], v[12:15]
    ds_read_b128 v[56:59], v6 offset:19328
    ds_read_b128 v[132:135], v4 offset:3072
    v_mfma_f32_16x16x32_bf16 v[16:19], a[148:151], v[60:63], v[16:19]
    v_lshlrev_b32 v72, 16, v120
    v_and_b32 v73, 0xffff0000, v120
    v_mfma_f32_16x16x32_bf16 v[20:23], a[152:155], v[60:63], v[20:23]
    v_lshlrev_b32 v74, 16, v121
    v_and_b32 v75, 0xffff0000, v121
    v_mfma_f32_16x16x32_bf16 v[12:15], a[156:159], v[64:67], v[12:15]
    ds_read_b128 v[60:63], v7 offset:19200
    ds_read_b64 v[136:137], v11 offset:3072
    v_mfma_f32_16x16x32_bf16 v[16:19], a[160:163], v[64:67], v[16:19]
    v_lshlrev_b32 v76, 16, v122
    v_and_b32 v77, 0xffff0000, v122
    v_mfma_f32_16x16x32_bf16 v[20:23], a[164:167], v[64:67], v[20:23]
    v_lshlrev_b32 v78, 16, v123
    v_and_b32 v79, 0xffff0000, v123
    v_mfma_f32_16x16x32_bf16 v[12:15], a[168:171], v[68:71], v[12:15]
    ds_read_b128 v[64:67], v7 offset:19264
    ds_read_b128 v[108:111], v3 offset:6144
    v_mfma_f32_16x16x32_bf16 v[16:19], a[172:175], v[68:71], v[16:19]
    v_lshlrev_b32 v80, 16, v124
    v_and_b32 v81, 0xffff0000, v124
    v_mfma_f32_16x16x32_bf16 v[20:23], a[176:179], v[68:71], v[20:23]
    v_lshlrev_b32 v82, 16, v125
    v_and_b32 v83, 0xffff0000, v125
    s_waitcnt lgkmcnt(15)
    v_mfma_f32_16x16x32_bf16 v[12:15], a[180:183], v[244:247], v[12:15]
    ds_read_b128 v[68:71], v7 offset:19328
    v_mfma_f32_16x16x32_bf16 v[16:19], a[184:187], v[244:247], v[16:19]
    ds_read_b128 v[112:115], v3 offset:6208
    v_mfma_f32_16x16x32_bf16 v[20:23], a[188:191], v[244:247], v[20:23]
    v_mfma_f32_16x16x32_bf16 v[72:75], v[140:143], v[84:87], v[72:75]
    s_waitcnt lgkmcnt(15)
    v_mfma_f32_16x16x32_bf16 v[12:15], a[192:195], v[248:251], v[12:15]
    ds_read_b128 v[244:247], v8 offset:19200
    v_mfma_f32_16x16x32_bf16 v[16:19], a[196:199], v[248:251], v[16:19]
    ds_read_b128 v[116:119], v3 offset:6272
    v_mfma_f32_16x16x32_bf16 v[20:23], a[200:203], v[248:251], v[20:23]
    v_mfma_f32_16x16x32_bf16 v[76:79], v[144:147], v[84:87], v[76:79]
    s_waitcnt lgkmcnt(15)
    v_mfma_f32_16x16x32_bf16 v[12:15], a[204:207], v[252:255], v[12:15]
    ds_read_b128 v[248:251], v8 offset:19264
    v_mfma_f32_16x16x32_bf16 v[16:19], a[208:211], v[252:255], v[16:19]
    v_mfma_f32_16x16x32_bf16 v[20:23], a[212:215], v[252:255], v[20:23]
    v_mfma_f32_16x16x32_bf16 v[80:83], v[148:151], v[84:87], v[80:83]
    s_waitcnt lgkmcnt(14)
    v_mfma_f32_16x16x32_bf16 v[12:15], a[216:219], v[48:51], v[12:15]
    ds_read_b128 v[252:255], v8 offset:19328
    v_mfma_f32_16x16x32_bf16 v[16:19], a[220:223], v[48:51], v[16:19]
    v_mfma_f32_16x16x32_bf16 v[20:23], a[224:227], v[48:51], v[20:23]
    v_mfma_f32_16x16x32_bf16 v[72:75], v[152:155], v[88:91], v[72:75]
    s_waitcnt lgkmcnt(13)
    v_mfma_f32_16x16x32_bf16 v[12:15], a[228:231], v[52:55], v[12:15]
    ds_read_b128 v[48:51], v6 offset:3072
    v_mfma_f32_16x16x32_bf16 v[16:19], a[232:235], v[52:55], v[16:19]
    v_mfma_f32_16x16x32_bf16 v[20:23], a[236:239], v[52:55], v[20:23]
    v_mfma_f32_16x16x32_bf16 v[76:79], v[156:159], v[88:91], v[76:79]
    s_waitcnt lgkmcnt(12)
    v_mfma_f32_16x16x32_bf16 v[12:15], a[240:243], v[56:59], v[12:15]
    ds_read_b128 v[52:55], v6 offset:3136
    v_mfma_f32_16x16x32_bf16 v[16:19], a[244:247], v[56:59], v[16:19]
    v_mfma_f32_16x16x32_bf16 v[20:23], a[248:251], v[56:59], v[20:23]
    v_mfma_f32_16x16x32_bf16 v[80:83], v[160:163], v[88:91], v[80:83]
    s_waitcnt lgkmcnt(11)
    v_mfma_f32_16x16x32_bf16 v[12:15], a[252:255], v[60:63], v[12:15]
    ds_read_b128 v[56:59], v6 offset:3200
    v_mfma_f32_16x16x32_bf16 v[16:19], v[176:179], v[60:63], v[16:19]
    v_mfma_f32_16x16x32_bf16 v[20:23], v[180:183], v[60:63], v[20:23]
    v_mfma_f32_16x16x32_bf16 v[72:75], v[164:167], v[92:95], v[72:75]
    s_waitcnt lgkmcnt(10)
    v_mfma_f32_16x16x32_bf16 v[12:15], v[184:187], v[64:67], v[12:15]
    ds_read_b128 v[60:63], v7 offset:3072
    v_mfma_f32_16x16x32_bf16 v[16:19], v[188:191], v[64:67], v[16:19]
    v_mfma_f32_16x16x32_bf16 v[20:23], v[192:195], v[64:67], v[20:23]
    v_mfma_f32_16x16x32_bf16 v[76:79], v[168:171], v[92:95], v[76:79]
    s_waitcnt lgkmcnt(9)
    v_mfma_f32_16x16x32_bf16 v[12:15], v[196:199], v[68:71], v[12:15]
    ds_read_b128 v[64:67], v7 offset:3136
    v_mfma_f32_16x16x32_bf16 v[16:19], v[200:203], v[68:71], v[16:19]
    v_mfma_f32_16x16x32_bf16 v[20:23], v[204:207], v[68:71], v[20:23]
    v_mfma_f32_16x16x32_bf16 v[80:83], v[172:175], v[92:95], v[80:83]
    s_waitcnt lgkmcnt(8)
    v_mfma_f32_16x16x32_bf16 v[12:15], v[208:211], v[244:247], v[12:15]
    ds_read_b128 v[68:71], v7 offset:3200
    v_mfma_f32_16x16x32_bf16 v[16:19], v[212:215], v[244:247], v[16:19]
    v_mfma_f32_16x16x32_bf16 v[20:23], v[216:219], v[244:247], v[20:23]
    s_waitcnt lgkmcnt(7)
    v_mfma_f32_16x16x32_bf16 v[12:15], v[220:223], v[248:251], v[12:15]
    ds_read_b128 v[244:247], v8 offset:3072
    v_mfma_f32_16x16x32_bf16 v[16:19], v[224:227], v[248:251], v[16:19]
    v_mfma_f32_16x16x32_bf16 v[20:23], v[228:231], v[248:251], v[20:23]
    s_barrier
    s_waitcnt lgkmcnt(7)
    v_mfma_f32_16x16x32_bf16 v[12:15], v[232:235], v[252:255], v[12:15]
    ds_read_b128 v[248:251], v8 offset:3136
    v_cvt_pk_bf16_f32 v72, v72, v73
    v_mfma_f32_16x16x32_bf16 v[16:19], v[236:239], v[252:255], v[16:19]
    v_cvt_pk_bf16_f32 v73, v74, v75
    v_cvt_pk_bf16_f32 v74, v76, v77
    v_mfma_f32_16x16x32_bf16 v[20:23], v[240:243], v[252:255], v[20:23]
    v_cvt_pk_bf16_f32 v75, v78, v79
    s_waitcnt lgkmcnt(7)
    v_mfma_f32_16x16x32_bf16 v[24:27], a[0:3], v[48:51], 0
    ds_read_b128 v[252:255], v8 offset:3200
    s_cmp_ge_u32 s37, 2
    s_cselect_b32 s30, 0x40000000, s30
    v_mfma_f32_16x16x32_bf16 v[28:31], a[4:7], v[48:51], 0
    s_cselect_b32 s31, 0x30000, s31
    s_cselect_b32 s32, 0x40000000, s32
    s_cselect_b32 s33, 0x30000, s33
    v_mfma_f32_16x16x32_bf16 v[32:35], a[8:11], v[48:51], 0
    ds_write_b128 v9, v[72:75] offset:0
    v_cvt_pk_bf16_f32 v80, v80, v81
    v_cvt_pk_bf16_f32 v81, v82, v83
    s_waitcnt lgkmcnt(8)
    v_mfma_f32_16x16x32_bf16 v[24:27], a[12:15], v[52:55], v[24:27]
    ds_read_b128 v[48:51], v6 offset:12672
    v_mfma_f32_16x16x32_bf16 v[28:31], a[16:19], v[52:55], v[28:31]
    ds_write_b64 v10, v[80:81] offset:0
    v_mfma_f32_16x16x32_bf16 v[32:35], a[20:23], v[52:55], v[32:35]
    s_waitcnt lgkmcnt(9)
    v_mfma_f32_16x16x32_bf16 v[24:27], a[24:27], v[56:59], v[24:27]
    ds_read_b128 v[52:55], v6 offset:12736
    v_mfma_f32_16x16x32_bf16 v[28:31], a[28:31], v[56:59], v[28:31]
    v_mfma_f32_16x16x32_bf16 v[32:35], a[32:35], v[56:59], v[32:35]
    s_waitcnt lgkmcnt(9)
    v_mfma_f32_16x16x32_bf16 v[24:27], a[36:39], v[60:63], v[24:27]
    ds_read_b128 v[56:59], v6 offset:12800
    v_mfma_f32_16x16x32_bf16 v[28:31], a[40:43], v[60:63], v[28:31]
    v_cvt_pk_bf16_f32 v12, v12, v13
    v_mfma_f32_16x16x32_bf16 v[32:35], a[44:47], v[60:63], v[32:35]
    v_cvt_pk_bf16_f32 v13, v14, v15
    s_waitcnt lgkmcnt(9)
    v_mfma_f32_16x16x32_bf16 v[24:27], a[48:51], v[64:67], v[24:27]
    ds_read_b128 v[60:63], v7 offset:12672
    v_mfma_f32_16x16x32_bf16 v[28:31], a[52:55], v[64:67], v[28:31]
    v_cvt_pk_bf16_f32 v14, v16, v17
    v_mfma_f32_16x16x32_bf16 v[32:35], a[56:59], v[64:67], v[32:35]
    v_cvt_pk_bf16_f32 v15, v18, v19
    s_waitcnt lgkmcnt(9)
    v_mfma_f32_16x16x32_bf16 v[24:27], a[60:63], v[68:71], v[24:27]
    ds_read_b128 v[64:67], v7 offset:12736
    v_mfma_f32_16x16x32_bf16 v[28:31], a[64:67], v[68:71], v[28:31]
    buffer_store_dwordx4 v[12:15], v5, s[20:23], s34 offen
    v_mfma_f32_16x16x32_bf16 v[32:35], a[68:71], v[68:71], v[32:35]
    s_waitcnt lgkmcnt(9)
    v_mfma_f32_16x16x32_bf16 v[24:27], a[72:75], v[244:247], v[24:27]
    ds_read_b128 v[68:71], v7 offset:12800
    v_mfma_f32_16x16x32_bf16 v[28:31], a[76:79], v[244:247], v[28:31]
    v_mfma_f32_16x16x32_bf16 v[32:35], a[80:83], v[244:247], v[32:35]
    s_waitcnt lgkmcnt(9)
    v_mfma_f32_16x16x32_bf16 v[24:27], a[84:87], v[248:251], v[24:27]
    ds_read_b128 v[244:247], v8 offset:12672
    v_cvt_pk_bf16_f32 v20, v20, v21
    v_cvt_pk_bf16_f32 v21, v22, v23
    v_mfma_f32_16x16x32_bf16 v[28:31], a[88:91], v[248:251], v[28:31]
    v_lshlrev_b32 v72, 16, v126
    v_and_b32 v73, 0xffff0000, v126
    v_mfma_f32_16x16x32_bf16 v[32:35], a[92:95], v[248:251], v[32:35]
    v_lshlrev_b32 v74, 16, v127
    v_and_b32 v75, 0xffff0000, v127
    s_waitcnt lgkmcnt(9)
    v_mfma_f32_16x16x32_bf16 v[24:27], a[96:99], v[252:255], v[24:27]
    ds_read_b128 v[248:251], v8 offset:12736
    buffer_store_dwordx2 v[20:21], v2, s[20:23], s34 offen
    v_mfma_f32_16x16x32_bf16 v[28:31], a[100:103], v[252:255], v[28:31]
    v_lshlrev_b32 v76, 16, v128
    v_and_b32 v77, 0xffff0000, v128
    v_mfma_f32_16x16x32_bf16 v[32:35], a[104:107], v[252:255], v[32:35]
    v_lshlrev_b32 v78, 16, v129
    v_and_b32 v79, 0xffff0000, v129
    s_waitcnt lgkmcnt(8)
    v_mfma_f32_16x16x32_bf16 v[24:27], a[108:111], v[48:51], v[24:27]
    ds_read_b128 v[252:255], v8 offset:12800
    s_add_u32 s34, s34, s57
    v_mfma_f32_16x16x32_bf16 v[28:31], a[112:115], v[48:51], v[28:31]
    v_lshlrev_b32 v80, 16, v130
    v_and_b32 v81, 0xffff0000, v130
    v_mfma_f32_16x16x32_bf16 v[32:35], a[116:119], v[48:51], v[32:35]
    v_lshlrev_b32 v82, 16, v131
    v_and_b32 v83, 0xffff0000, v131
    s_waitcnt lgkmcnt(7)
    v_mfma_f32_16x16x32_bf16 v[24:27], a[120:123], v[52:55], v[24:27]
    ds_read_b128 v[48:51], v6 offset:22272
    v_mfma_f32_16x16x32_bf16 v[28:31], a[124:127], v[52:55], v[28:31]
    v_mfma_f32_16x16x32_bf16 v[32:35], a[128:131], v[52:55], v[32:35]
    v_mfma_f32_16x16x32_bf16 v[72:75], v[140:143], v[96:99], v[72:75]
    s_waitcnt lgkmcnt(7)
    v_mfma_f32_16x16x32_bf16 v[24:27], a[132:135], v[56:59], v[24:27]
    ds_read_b128 v[52:55], v6 offset:22336
    s_add_u32 m0, s60, s31
    v_mfma_f32_16x16x32_bf16 v[28:31], a[136:139], v[56:59], v[28:31]
    s_nop 0
    v_mfma_f32_16x16x32_bf16 v[32:35], a[140:143], v[56:59], v[32:35]
    buffer_load_dwordx4 v1, s[4:7], s30 offen offset:0 nt lds
    v_mfma_f32_16x16x32_bf16 v[76:79], v[144:147], v[96:99], v[76:79]
    s_waitcnt lgkmcnt(7)
    v_mfma_f32_16x16x32_bf16 v[24:27], a[144:147], v[60:63], v[24:27]
    ds_read_b128 v[56:59], v6 offset:22400
    v_mfma_f32_16x16x32_bf16 v[28:31], a[148:151], v[60:63], v[28:31]
    v_mfma_f32_16x16x32_bf16 v[32:35], a[152:155], v[60:63], v[32:35]
    v_mfma_f32_16x16x32_bf16 v[80:83], v[148:151], v[96:99], v[80:83]
    s_waitcnt lgkmcnt(7)
    v_mfma_f32_16x16x32_bf16 v[24:27], a[156:159], v[64:67], v[24:27]
    ds_read_b128 v[60:63], v7 offset:22272
    v_mfma_f32_16x16x32_bf16 v[28:31], a[160:163], v[64:67], v[28:31]
    buffer_load_dwordx4 v1, s[4:7], s30 offen offset:1024 nt lds
    v_mfma_f32_16x16x32_bf16 v[32:35], a[164:167], v[64:67], v[32:35]
    v_mfma_f32_16x16x32_bf16 v[72:75], v[152:155], v[100:103], v[72:75]
    s_waitcnt lgkmcnt(7)
    v_mfma_f32_16x16x32_bf16 v[24:27], a[168:171], v[68:71], v[24:27]
    ds_read_b128 v[64:67], v7 offset:22336
    v_mfma_f32_16x16x32_bf16 v[28:31], a[172:175], v[68:71], v[28:31]
    v_mfma_f32_16x16x32_bf16 v[32:35], a[176:179], v[68:71], v[32:35]
    v_mfma_f32_16x16x32_bf16 v[76:79], v[156:159], v[100:103], v[76:79]
    s_waitcnt lgkmcnt(7)
    v_mfma_f32_16x16x32_bf16 v[24:27], a[180:183], v[244:247], v[24:27]
    ds_read_b128 v[68:71], v7 offset:22400
    v_mfma_f32_16x16x32_bf16 v[28:31], a[184:187], v[244:247], v[28:31]
    buffer_load_dwordx4 v1, s[4:7], s30 offen offset:2048 nt lds
    v_mfma_f32_16x16x32_bf16 v[32:35], a[188:191], v[244:247], v[32:35]
    v_mfma_f32_16x16x32_bf16 v[80:83], v[160:163], v[100:103], v[80:83]
    s_waitcnt lgkmcnt(7)
    v_mfma_f32_16x16x32_bf16 v[24:27], a[192:195], v[248:251], v[24:27]
    ds_read_b128 v[244:247], v8 offset:22272
    v_mfma_f32_16x16x32_bf16 v[28:31], a[196:199], v[248:251], v[28:31]
    v_mfma_f32_16x16x32_bf16 v[32:35], a[200:203], v[248:251], v[32:35]
    v_mfma_f32_16x16x32_bf16 v[72:75], v[164:167], v[104:107], v[72:75]
    s_waitcnt lgkmcnt(7)
    v_mfma_f32_16x16x32_bf16 v[24:27], a[204:207], v[252:255], v[24:27]
    ds_read_b128 v[248:251], v8 offset:22336
    v_mfma_f32_16x16x32_bf16 v[28:31], a[208:211], v[252:255], v[28:31]
    buffer_load_dwordx4 v1, s[4:7], s30 offen offset:3072 nt lds
    v_mfma_f32_16x16x32_bf16 v[32:35], a[212:215], v[252:255], v[32:35]
    v_mfma_f32_16x16x32_bf16 v[76:79], v[168:171], v[104:107], v[76:79]
    s_waitcnt lgkmcnt(7)
    v_mfma_f32_16x16x32_bf16 v[24:27], a[216:219], v[48:51], v[24:27]
    ds_read_b128 v[252:255], v8 offset:22400
    v_mfma_f32_16x16x32_bf16 v[28:31], a[220:223], v[48:51], v[28:31]
    v_mfma_f32_16x16x32_bf16 v[32:35], a[224:227], v[48:51], v[32:35]
    v_mfma_f32_16x16x32_bf16 v[80:83], v[172:175], v[104:107], v[80:83]
    s_waitcnt lgkmcnt(7)
    v_mfma_f32_16x16x32_bf16 v[24:27], a[228:231], v[52:55], v[24:27]
    ds_read_b128 v[48:51], v6 offset:6144
    s_add_u32 m0, m0, 4096
    v_mfma_f32_16x16x32_bf16 v[28:31], a[232:235], v[52:55], v[28:31]
    s_add_u32 s55, s30, 4096
    v_mfma_f32_16x16x32_bf16 v[32:35], a[236:239], v[52:55], v[32:35]
    s_mov_b64 exec, 0xffffffff
    buffer_load_dwordx4 v1, s[4:7], s55 offen nt lds
    s_mov_b64 exec, -1
    s_waitcnt lgkmcnt(7)
    v_mfma_f32_16x16x32_bf16 v[24:27], a[240:243], v[56:59], v[24:27]
    ds_read_b128 v[52:55], v6 offset:6208
    v_mfma_f32_16x16x32_bf16 v[28:31], a[244:247], v[56:59], v[28:31]
    v_mfma_f32_16x16x32_bf16 v[32:35], a[248:251], v[56:59], v[32:35]
    s_waitcnt lgkmcnt(7)
    v_mfma_f32_16x16x32_bf16 v[24:27], a[252:255], v[60:63], v[24:27]
    ds_read_b128 v[56:59], v6 offset:6272
    s_add_u32 s30, s30, s57
    s_add_u32 s31, s31, 19200
    s_add_u32 m0, s33, s62
    v_mfma_f32_16x16x32_bf16 v[28:31], v[176:179], v[60:63], v[28:31]
    s_add_u32 s55, s32, s62
    buffer_load_dwordx4 v1, s[8:11], s55 offen nt lds
    v_cvt_pk_bf16_f32 v72, v72, v73
    v_mfma_f32_16x16x32_bf16 v[32:35], v[180:183], v[60:63], v[32:35]
    v_cvt_pk_bf16_f32 v73, v74, v75
    v_cvt_pk_bf16_f32 v74, v76, v77
    v_cvt_pk_bf16_f32 v75, v78, v79
    s_waitcnt lgkmcnt(7)
    v_mfma_f32_16x16x32_bf16 v[24:27], v[184:187], v[64:67], v[24:27]
    ds_read_b128 v[60:63], v7 offset:6144
    ds_write_b128 v9, v[72:75] offset:3072
    v_mfma_f32_16x16x32_bf16 v[28:31], v[188:191], v[64:67], v[28:31]
    v_cvt_pk_bf16_f32 v80, v80, v81
    v_mfma_f32_16x16x32_bf16 v[32:35], v[192:195], v[64:67], v[32:35]
    v_cvt_pk_bf16_f32 v81, v82, v83
    s_waitcnt lgkmcnt(8)
    v_mfma_f32_16x16x32_bf16 v[24:27], v[196:199], v[68:71], v[24:27]
    ds_read_b128 v[64:67], v7 offset:6208
    s_add_u32 m0, s33, s63
    v_mfma_f32_16x16x32_bf16 v[28:31], v[200:203], v[68:71], v[28:31]
    s_add_u32 s55, s32, s63
    s_mov_b64 exec, 0xff
    buffer_load_dwordx4 v1, s[8:11], s55 offen nt lds
    s_mov_b64 exec, -1
    v_mfma_f32_16x16x32_bf16 v[32:35], v[204:207], v[68:71], v[32:35]
    ds_write_b64 v10, v[80:81] offset:3072
    s_waitcnt lgkmcnt(9)
    v_mfma_f32_16x16x32_bf16 v[24:27], v[208:211], v[244:247], v[24:27]
    ds_read_b128 v[68:71], v7 offset:6272
    v_mfma_f32_16x16x32_bf16 v[28:31], v[212:215], v[244:247], v[28:31]
    v_mfma_f32_16x16x32_bf16 v[32:35], v[216:219], v[244:247], v[32:35]
    s_waitcnt lgkmcnt(9)
    v_mfma_f32_16x16x32_bf16 v[24:27], v[220:223], v[248:251], v[24:27]
    ds_read_b128 v[244:247], v8 offset:6144
    s_add_u32 s32, s32, s58
    v_mfma_f32_16x16x32_bf16 v[28:31], v[224:227], v[248:251], v[28:31]
    s_add_u32 s33, s33, 4608
    s_cmp_eq_u32 s33, 162240
    v_mfma_f32_16x16x32_bf16 v[32:35], v[228:231], v[248:251], v[32:35]
    s_cselect_b32 s33, 134592, s33
    s_waitcnt lgkmcnt(9)
    v_mfma_f32_16x16x32_bf16 v[24:27], v[232:235], v[252:255], v[24:27]
    ds_read_b128 v[248:251], v8 offset:6208
    v_mfma_f32_16x16x32_bf16 v[28:31], v[236:239], v[252:255], v[28:31]
    v_mfma_f32_16x16x32_bf16 v[32:35], v[240:243], v[252:255], v[32:35]
    s_waitcnt lgkmcnt(9)
    v_mfma_f32_16x16x32_bf16 v[36:39], a[0:3], v[48:51], 0
    ds_read_b128 v[252:255], v8 offset:6272
    v_mfma_f32_16x16x32_bf16 v[40:43], a[4:7], v[48:51], 0
    v_mfma_f32_16x16x32_bf16 v[44:47], a[8:11], v[48:51], 0
    s_waitcnt lgkmcnt(9)
    v_mfma_f32_16x16x32_bf16 v[36:39], a[12:15], v[52:55], v[36:39]
    ds_read_b128 v[48:51], v6 offset:15744
    v_mfma_f32_16x16x32_bf16 v[40:43], a[16:19], v[52:55], v[40:43]
    v_mfma_f32_16x16x32_bf16 v[44:47], a[20:23], v[52:55], v[44:47]
    s_waitcnt lgkmcnt(9)
    v_mfma_f32_16x16x32_bf16 v[36:39], a[24:27], v[56:59], v[36:39]
    ds_read_b128 v[52:55], v6 offset:15808
    v_lshlrev_b32 v72, 16, v132
    v_mfma_f32_16x16x32_bf16 v[40:43], a[28:31], v[56:59], v[40:43]
    v_and_b32 v73, 0xffff0000, v132
    v_lshlrev_b32 v74, 16, v133
    v_mfma_f32_16x16x32_bf16 v[44:47], a[32:35], v[56:59], v[44:47]
    v_and_b32 v75, 0xffff0000, v133
    s_waitcnt lgkmcnt(9)
    v_mfma_f32_16x16x32_bf16 v[36:39], a[36:39], v[60:63], v[36:39]
    ds_read_b128 v[56:59], v6 offset:15872
    v_cvt_pk_bf16_f32 v24, v24, v25
    v_cvt_pk_bf16_f32 v25, v26, v27
    v_mfma_f32_16x16x32_bf16 v[40:43], a[40:43], v[60:63], v[40:43]
    v_lshlrev_b32 v76, 16, v134
    v_and_b32 v77, 0xffff0000, v134
    v_mfma_f32_16x16x32_bf16 v[44:47], a[44:47], v[60:63], v[44:47]
    v_lshlrev_b32 v78, 16, v135
    v_and_b32 v79, 0xffff0000, v135
    s_waitcnt lgkmcnt(8)
    v_mfma_f32_16x16x32_bf16 v[36:39], a[48:51], v[64:67], v[36:39]
    ds_read_b128 v[60:63], v7 offset:15744
    v_cvt_pk_bf16_f32 v26, v28, v29
    v_cvt_pk_bf16_f32 v27, v30, v31
    v_mfma_f32_16x16x32_bf16 v[40:43], a[52:55], v[64:67], v[40:43]
    v_lshlrev_b32 v80, 16, v136
    v_and_b32 v81, 0xffff0000, v136
    v_mfma_f32_16x16x32_bf16 v[44:47], a[56:59], v[64:67], v[44:47]
    v_lshlrev_b32 v82, 16, v137
    v_and_b32 v83, 0xffff0000, v137
    s_waitcnt lgkmcnt(7)
    v_mfma_f32_16x16x32_bf16 v[36:39], a[60:63], v[68:71], v[36:39]
    ds_read_b128 v[64:67], v7 offset:15808
    v_mfma_f32_16x16x32_bf16 v[40:43], a[64:67], v[68:71], v[40:43]
    buffer_store_dwordx4 v[24:27], v5, s[20:23], s35 offen
    v_mfma_f32_16x16x32_bf16 v[44:47], a[68:71], v[68:71], v[44:47]
    v_mfma_f32_16x16x32_bf16 v[72:75], v[140:143], v[108:111], v[72:75]
    s_waitcnt lgkmcnt(7)
    v_mfma_f32_16x16x32_bf16 v[36:39], a[72:75], v[244:247], v[36:39]
    ds_read_b128 v[68:71], v7 offset:15872
    v_mfma_f32_16x16x32_bf16 v[40:43], a[76:79], v[244:247], v[40:43]
    v_mfma_f32_16x16x32_bf16 v[44:47], a[80:83], v[244:247], v[44:47]
    v_mfma_f32_16x16x32_bf16 v[76:79], v[144:147], v[108:111], v[76:79]
    s_waitcnt lgkmcnt(7)
    v_mfma_f32_16x16x32_bf16 v[36:39], a[84:87], v[248:251], v[36:39]
    ds_read_b128 v[244:247], v8 offset:15744
    v_mfma_f32_16x16x32_bf16 v[40:43], a[88:91], v[248:251], v[40:43]
    v_cvt_pk_bf16_f32 v32, v32, v33
    v_mfma_f32_16x16x32_bf16 v[44:47], a[92:95], v[248:251], v[44:47]
    v_cvt_pk_bf16_f32 v33, v34, v35
    v_mfma_f32_16x16x32_bf16 v[80:83], v[148:151], v[108:111], v[80:83]
    s_waitcnt lgkmcnt(7)
    v_mfma_f32_16x16x32_bf16 v[36:39], a[96:99], v[252:255], v[36:39]
    ds_read_b128 v[248:251], v8 offset:15808
    v_mfma_f32_16x16x32_bf16 v[40:43], a[100:103], v[252:255], v[40:43]
    buffer_store_dwordx2 v[32:33], v2, s[20:23], s35 offen
    v_mfma_f32_16x16x32_bf16 v[44:47], a[104:107], v[252:255], v[44:47]
    v_mfma_f32_16x16x32_bf16 v[72:75], v[152:155], v[112:115], v[72:75]
    s_waitcnt lgkmcnt(7)
    v_mfma_f32_16x16x32_bf16 v[36:39], a[108:111], v[48:51], v[36:39]
    ds_read_b128 v[252:255], v8 offset:15872
    v_mfma_f32_16x16x32_bf16 v[40:43], a[112:115], v[48:51], v[40:43]
    s_add_u32 s35, s35, s57
    v_mfma_f32_16x16x32_bf16 v[44:47], a[116:119], v[48:51], v[44:47]
    v_mfma_f32_16x16x32_bf16 v[76:79], v[156:159], v[112:115], v[76:79]
    s_waitcnt lgkmcnt(7)
    v_mfma_f32_16x16x32_bf16 v[36:39], a[120:123], v[52:55], v[36:39]
    ds_read_b128 v[48:51], v6 offset:25344
    v_mfma_f32_16x16x32_bf16 v[40:43], a[124:127], v[52:55], v[40:43]
    v_mfma_f32_16x16x32_bf16 v[44:47], a[128:131], v[52:55], v[44:47]
    v_mfma_f32_16x16x32_bf16 v[80:83], v[160:163], v[112:115], v[80:83]
    s_waitcnt lgkmcnt(7)
    v_mfma_f32_16x16x32_bf16 v[36:39], a[132:135], v[56:59], v[36:39]
    ds_read_b128 v[52:55], v6 offset:25408
    v_mfma_f32_16x16x32_bf16 v[40:43], a[136:139], v[56:59], v[40:43]
    v_mfma_f32_16x16x32_bf16 v[44:47], a[140:143], v[56:59], v[44:47]
    v_mfma_f32_16x16x32_bf16 v[72:75], v[164:167], v[116:119], v[72:75]
    s_waitcnt lgkmcnt(7)
    v_mfma_f32_16x16x32_bf16 v[36:39], a[144:147], v[60:63], v[36:39]
    ds_read_b128 v[56:59], v6 offset:25472
    v_mfma_f32_16x16x32_bf16 v[40:43], a[148:151], v[60:63], v[40:43]
    v_mfma_f32_16x16x32_bf16 v[44:47], a[152:155], v[60:63], v[44:47]
    v_mfma_f32_16x16x32_bf16 v[76:79], v[168:171], v[116:119], v[76:79]
    s_waitcnt lgkmcnt(7)
    v_mfma_f32_16x16x32_bf16 v[36:39], a[156:159], v[64:67], v[36:39]
    ds_read_b128 v[60:63], v7 offset:25344
    v_mfma_f32_16x16x32_bf16 v[40:43], a[160:163], v[64:67], v[40:43]
    v_mfma_f32_16x16x32_bf16 v[44:47], a[164:167], v[64:67], v[44:47]
    v_mfma_f32_16x16x32_bf16 v[80:83], v[172:175], v[116:119], v[80:83]
    s_waitcnt lgkmcnt(7)
    v_mfma_f32_16x16x32_bf16 v[36:39], a[168:171], v[68:71], v[36:39]
    ds_read_b128 v[64:67], v7 offset:25408
    v_mfma_f32_16x16x32_bf16 v[40:43], a[172:175], v[68:71], v[40:43]
    v_mfma_f32_16x16x32_bf16 v[44:47], a[176:179], v[68:71], v[44:47]
    s_waitcnt lgkmcnt(7)
    v_mfma_f32_16x16x32_bf16 v[36:39], a[180:183], v[244:247], v[36:39]
    ds_read_b128 v[68:71], v7 offset:25472
    v_mfma_f32_16x16x32_bf16 v[40:43], a[184:187], v[244:247], v[40:43]
    v_mfma_f32_16x16x32_bf16 v[44:47], a[188:191], v[244:247], v[44:47]
    s_waitcnt lgkmcnt(7)
    v_mfma_f32_16x16x32_bf16 v[36:39], a[192:195], v[248:251], v[36:39]
    ds_read_b128 v[244:247], v8 offset:25344
    v_cvt_pk_bf16_f32 v72, v72, v73
    v_mfma_f32_16x16x32_bf16 v[40:43], a[196:199], v[248:251], v[40:43]
    v_cvt_pk_bf16_f32 v73, v74, v75
    v_cvt_pk_bf16_f32 v74, v76, v77
    v_mfma_f32_16x16x32_bf16 v[44:47], a[200:203], v[248:251], v[44:47]
    v_cvt_pk_bf16_f32 v75, v78, v79
    s_waitcnt lgkmcnt(7)
    v_mfma_f32_16x16x32_bf16 v[36:39], a[204:207], v[252:255], v[36:39]
    ds_read_b128 v[248:251], v8 offset:25408
    ds_write_b128 v9, v[72:75] offset:6144
    v_mfma_f32_16x16x32_bf16 v[40:43], a[208:211], v[252:255], v[40:43]
    v_cvt_pk_bf16_f32 v80, v80, v81
    v_mfma_f32_16x16x32_bf16 v[44:47], a[212:215], v[252:255], v[44:47]
    v_cvt_pk_bf16_f32 v81, v82, v83
    s_waitcnt lgkmcnt(8)
    v_mfma_f32_16x16x32_bf16 v[36:39], a[216:219], v[48:51], v[36:39]
    ds_read_b128 v[252:255], v8 offset:25472
    v_mfma_f32_16x16x32_bf16 v[40:43], a[220:223], v[48:51], v[40:43]
    ds_write_b64 v10, v[80:81] offset:6144
    v_mfma_f32_16x16x32_bf16 v[44:47], a[224:227], v[48:51], v[44:47]
    s_waitcnt lgkmcnt(9)
    v_mfma_f32_16x16x32_bf16 v[36:39], a[228:231], v[52:55], v[36:39]
    ds_read_b128 v[48:51], v6 offset:19200
    v_mfma_f32_16x16x32_bf16 v[40:43], a[232:235], v[52:55], v[40:43]
    v_mfma_f32_16x16x32_bf16 v[44:47], a[236:239], v[52:55], v[44:47]
    s_waitcnt lgkmcnt(9)
    v_mfma_f32_16x16x32_bf16 v[36:39], a[240:243], v[56:59], v[36:39]
    ds_read_b128 v[52:55], v6 offset:19264
    v_mfma_f32_16x16x32_bf16 v[40:43], a[244:247], v[56:59], v[40:43]
    v_mfma_f32_16x16x32_bf16 v[44:47], a[248:251], v[56:59], v[44:47]
    s_waitcnt lgkmcnt(9)
    v_mfma_f32_16x16x32_bf16 v[36:39], a[252:255], v[60:63], v[36:39]
    ds_read_b128 v[56:59], v6 offset:19328
    v_mfma_f32_16x16x32_bf16 v[40:43], v[176:179], v[60:63], v[40:43]
    v_mfma_f32_16x16x32_bf16 v[44:47], v[180:183], v[60:63], v[44:47]
    s_waitcnt lgkmcnt(9)
    v_mfma_f32_16x16x32_bf16 v[36:39], v[184:187], v[64:67], v[36:39]
    ds_read_b128 v[60:63], v7 offset:19200
    s_mov_b32 s53, 4608
    v_mfma_f32_16x16x32_bf16 v[40:43], v[188:191], v[64:67], v[40:43]
    s_add_u32 s59, s59, 1
    s_cmp_eq_u32 s59, 6
    v_mfma_f32_16x16x32_bf16 v[44:47], v[192:195], v[64:67], v[44:47]
    s_cselect_b32 s53, 0xffffa600, s53
    s_waitcnt lgkmcnt(9)
    v_mfma_f32_16x16x32_bf16 v[36:39], v[196:199], v[68:71], v[36:39]
    ds_read_b128 v[64:67], v7 offset:19264
    v_mfma_f32_16x16x32_bf16 v[40:43], v[200:203], v[68:71], v[40:43]
    v_mfma_f32_16x16x32_bf16 v[44:47], v[204:207], v[68:71], v[44:47]
    s_waitcnt lgkmcnt(9)
    v_mfma_f32_16x16x32_bf16 v[36:39], v[208:211], v[244:247], v[36:39]
    ds_read_b128 v[68:71], v7 offset:19328
    v_mfma_f32_16x16x32_bf16 v[40:43], v[212:215], v[244:247], v[40:43]
    v_add_u32 v4, s53, v4
    v_mfma_f32_16x16x32_bf16 v[44:47], v[216:219], v[244:247], v[44:47]
    v_add_u32 v11, s53, v11
    s_waitcnt lgkmcnt(9)
    v_mfma_f32_16x16x32_bf16 v[36:39], v[220:223], v[248:251], v[36:39]
    ds_read_b128 v[244:247], v8 offset:19200
    v_mfma_f32_16x16x32_bf16 v[40:43], v[224:227], v[248:251], v[40:43]
    v_mfma_f32_16x16x32_bf16 v[44:47], v[228:231], v[248:251], v[44:47]
    s_waitcnt lgkmcnt(8)
    v_mfma_f32_16x16x32_bf16 v[36:39], v[232:235], v[252:255], v[36:39]
    ds_read_b128 v[248:251], v8 offset:19264
    v_mfma_f32_16x16x32_bf16 v[40:43], v[236:239], v[252:255], v[40:43]
    v_mfma_f32_16x16x32_bf16 v[44:47], v[240:243], v[252:255], v[44:47]
    v_add_u32 v9, 19200, v9
    v_add_u32 v10, 19200, v10
    v_add_u32 v3, 19200, v3
    v_add_u32 v6, 19200, v6
    v_add_u32 v7, 19200, v7
    v_add_u32 v8, 19200, v8
    s_add_u32 s37, s37, 1
    s_cmp_lt_u32 s37, 4
    s_cbranch_scc1 L_loop
    s_waitcnt lgkmcnt(7)
    v_mfma_f32_16x16x32_bf16 v[12:15], a[0:3], v[48:51], 0
    ds_read_b128 v[252:255], v8 offset:128
    v_mfma_f32_16x16x32_bf16 v[16:19], a[4:7], v[48:51], 0
    v_mfma_f32_16x16x32_bf16 v[20:23], a[8:11], v[48:51], 0
    s_waitcnt lgkmcnt(7)
    v_mfma_f32_16x16x32_bf16 v[12:15], a[12:15], v[52:55], v[12:15]
    s_barrier
    ds_read_b128 v[48:51], v6 offset:9600
    v_mfma_f32_16x16x32_bf16 v[16:19], a[16:19], v[52:55], v[16:19]
    v_mfma_f32_16x16x32_bf16 v[20:23], a[20:23], v[52:55], v[20:23]
    s_waitcnt lgkmcnt(7)
    v_mfma_f32_16x16x32_bf16 v[12:15], a[24:27], v[56:59], v[12:15]
    ds_read_b128 v[52:55], v6 offset:9664
    v_mfma_f32_16x16x32_bf16 v[16:19], a[28:31], v[56:59], v[16:19]
    v_mfma_f32_16x16x32_bf16 v[20:23], a[32:35], v[56:59], v[20:23]
    s_waitcnt lgkmcnt(7)
    v_mfma_f32_16x16x32_bf16 v[12:15], a[36:39], v[60:63], v[12:15]
    ds_read_b128 v[56:59], v6 offset:9728
    v_mfma_f32_16x16x32_bf16 v[16:19], a[40:43], v[60:63], v[16:19]
    v_cvt_pk_bf16_f32 v36, v36, v37
    v_mfma_f32_16x16x32_bf16 v[20:23], a[44:47], v[60:63], v[20:23]
    v_cvt_pk_bf16_f32 v37, v38, v39
    s_waitcnt lgkmcnt(7)
    v_mfma_f32_16x16x32_bf16 v[12:15], a[48:51], v[64:67], v[12:15]
    ds_read_b128 v[60:63], v7 offset:9600
    v_mfma_f32_16x16x32_bf16 v[16:19], a[52:55], v[64:67], v[16:19]
    v_cvt_pk_bf16_f32 v38, v40, v41
    v_mfma_f32_16x16x32_bf16 v[20:23], a[56:59], v[64:67], v[20:23]
    v_cvt_pk_bf16_f32 v39, v42, v43
    s_waitcnt lgkmcnt(7)
    v_mfma_f32_16x16x32_bf16 v[12:15], a[60:63], v[68:71], v[12:15]
    ds_read_b128 v[64:67], v7 offset:9664
    v_mfma_f32_16x16x32_bf16 v[16:19], a[64:67], v[68:71], v[16:19]
    buffer_store_dwordx4 v[36:39], v5, s[20:23], s36 offen
    v_mfma_f32_16x16x32_bf16 v[20:23], a[68:71], v[68:71], v[20:23]
    s_waitcnt lgkmcnt(7)
    v_mfma_f32_16x16x32_bf16 v[12:15], a[72:75], v[244:247], v[12:15]
    ds_read_b128 v[68:71], v7 offset:9728
    v_mfma_f32_16x16x32_bf16 v[16:19], a[76:79], v[244:247], v[16:19]
    v_mfma_f32_16x16x32_bf16 v[20:23], a[80:83], v[244:247], v[20:23]
    s_waitcnt lgkmcnt(7)
    v_mfma_f32_16x16x32_bf16 v[12:15], a[84:87], v[248:251], v[12:15]
    ds_read_b128 v[244:247], v8 offset:9600
    v_mfma_f32_16x16x32_bf16 v[16:19], a[88:91], v[248:251], v[16:19]
    v_cvt_pk_bf16_f32 v44, v44, v45
    v_mfma_f32_16x16x32_bf16 v[20:23], a[92:95], v[248:251], v[20:23]
    v_cvt_pk_bf16_f32 v45, v46, v47
    s_waitcnt lgkmcnt(7)
    v_mfma_f32_16x16x32_bf16 v[12:15], a[96:99], v[252:255], v[12:15]
    ds_read_b128 v[248:251], v8 offset:9664
    v_mfma_f32_16x16x32_bf16 v[16:19], a[100:103], v[252:255], v[16:19]
    buffer_store_dwordx2 v[44:45], v2, s[20:23], s36 offen
    v_mfma_f32_16x16x32_bf16 v[20:23], a[104:107], v[252:255], v[20:23]
    s_waitcnt lgkmcnt(7)
    v_mfma_f32_16x16x32_bf16 v[12:15], a[108:111], v[48:51], v[12:15]
    ds_read_b128 v[252:255], v8 offset:9728
    v_mfma_f32_16x16x32_bf16 v[16:19], a[112:115], v[48:51], v[16:19]
    s_add_u32 s36, s36, s57
    v_mfma_f32_16x16x32_bf16 v[20:23], a[116:119], v[48:51], v[20:23]
    s_waitcnt lgkmcnt(7)
    v_mfma_f32_16x16x32_bf16 v[12:15], a[120:123], v[52:55], v[12:15]
    ds_read_b128 v[48:51], v6 offset:19200
    v_mfma_f32_16x16x32_bf16 v[16:19], a[124:127], v[52:55], v[16:19]
    v_mfma_f32_16x16x32_bf16 v[20:23], a[128:131], v[52:55], v[20:23]
    s_waitcnt lgkmcnt(7)
    v_mfma_f32_16x16x32_bf16 v[12:15], a[132:135], v[56:59], v[12:15]
    ds_read_b128 v[52:55], v6 offset:19264
    v_mfma_f32_16x16x32_bf16 v[16:19], a[136:139], v[56:59], v[16:19]
    v_mfma_f32_16x16x32_bf16 v[20:23], a[140:143], v[56:59], v[20:23]
    s_waitcnt lgkmcnt(7)
    v_mfma_f32_16x16x32_bf16 v[12:15], a[144:147], v[60:63], v[12:15]
    ds_read_b128 v[56:59], v6 offset:19328
    v_mfma_f32_16x16x32_bf16 v[16:19], a[148:151], v[60:63], v[16:19]
    v_mfma_f32_16x16x32_bf16 v[20:23], a[152:155], v[60:63], v[20:23]
    s_waitcnt lgkmcnt(7)
    v_mfma_f32_16x16x32_bf16 v[12:15], a[156:159], v[64:67], v[12:15]
    ds_read_b128 v[60:63], v7 offset:19200
    v_mfma_f32_16x16x32_bf16 v[16:19], a[160:163], v[64:67], v[16:19]
    v_mfma_f32_16x16x32_bf16 v[20:23], a[164:167], v[64:67], v[20:23]
    s_waitcnt lgkmcnt(7)
    v_mfma_f32_16x16x32_bf16 v[12:15], a[168:171], v[68:71], v[12:15]
    ds_read_b128 v[64:67], v7 offset:19264
    v_mfma_f32_16x16x32_bf16 v[16:19], a[172:175], v[68:71], v[16:19]
    v_mfma_f32_16x16x32_bf16 v[20:23], a[176:179], v[68:71], v[20:23]
    s_waitcnt lgkmcnt(7)
    v_mfma_f32_16x16x32_bf16 v[12:15], a[180:183], v[244:247], v[12:15]
    ds_read_b128 v[68:71], v7 offset:19328
    v_mfma_f32_16x16x32_bf16 v[16:19], a[184:187], v[244:247], v[16:19]
    v_mfma_f32_16x16x32_bf16 v[20:23], a[188:191], v[244:247], v[20:23]
    s_waitcnt lgkmcnt(7)
    v_mfma_f32_16x16x32_bf16 v[12:15], a[192:195], v[248:251], v[12:15]
    ds_read_b128 v[244:247], v8 offset:19200
    v_mfma_f32_16x16x32_bf16 v[16:19], a[196:199], v[248:251], v[16:19]
    v_mfma_f32_16x16x32_bf16 v[20:23], a[200:203], v[248:251], v[20:23]
    s_waitcnt lgkmcnt(7)
    v_mfma_f32_16x16x32_bf16 v[12:15], a[204:207], v[252:255], v[12:15]
    ds_read_b128 v[248:251], v8 offset:19264
    v_mfma_f32_16x16x32_bf16 v[16:19], a[208:211], v[252:255], v[16:19]
    v_mfma_f32_16x16x32_bf16 v[20:23], a[212:215], v[252:255], v[20:23]
    s_waitcnt lgkmcnt(7)
    v_mfma_f32_16x16x32_bf16 v[12:15], a[216:219], v[48:51], v[12:15]
    ds_read_b128 v[252:255], v8 offset:19328
    v_mfma_f32_16x16x32_bf16 v[16:19], a[220:223], v[48:51], v[16:19]
    v_mfma_f32_16x16x32_bf16 v[20:23], a[224:227], v[48:51], v[20:23]
    s_waitcnt lgkmcnt(7)
    v_mfma_f32_16x16x32_bf16 v[12:15], a[228:231], v[52:55], v[12:15]
    ds_read_b128 v[48:51], v6 offset:3072
    v_mfma_f32_16x16x32_bf16 v[16:19], a[232:235], v[52:55], v[16:19]
    v_mfma_f32_16x16x32_bf16 v[20:23], a[236:239], v[52:55], v[20:23]
    s_waitcnt lgkmcnt(7)
    v_mfma_f32_16x16x32_bf16 v[12:15], a[240:243], v[56:59], v[12:15]
    ds_read_b128 v[52:55], v6 offset:3136
    v_mfma_f32_16x16x32_bf16 v[16:19], a[244:247], v[56:59], v[16:19]
    v_mfma_f32_16x16x32_bf16 v[20:23], a[248:251], v[56:59], v[20:23]
    s_waitcnt lgkmcnt(7)
    v_mfma_f32_16x16x32_bf16 v[12:15], a[252:255], v[60:63], v[12:15]
    ds_read_b128 v[56:59], v6 offset:3200
    v_mfma_f32_16x16x32_bf16 v[16:19], v[176:179], v[60:63], v[16:19]
    v_mfma_f32_16x16x32_bf16 v[20:23], v[180:183], v[60:63], v[20:23]
    s_waitcnt lgkmcnt(7)
    v_mfma_f32_16x16x32_bf16 v[12:15], v[184:187], v[64:67], v[12:15]
    ds_read_b128 v[60:63], v7 offset:3072
    v_mfma_f32_16x16x32_bf16 v[16:19], v[188:191], v[64:67], v[16:19]
    v_mfma_f32_16x16x32_bf16 v[20:23], v[192:195], v[64:67], v[20:23]
    s_waitcnt lgkmcnt(7)
    v_mfma_f32_16x16x32_bf16 v[12:15], v[196:199], v[68:71], v[12:15]
    ds_read_b128 v[64:67], v7 offset:3136
    v_mfma_f32_16x16x32_bf16 v[16:19], v[200:203], v[68:71], v[16:19]
    v_mfma_f32_16x16x32_bf16 v[20:23], v[204:207], v[68:71], v[20:23]
    s_waitcnt lgkmcnt(7)
    v_mfma_f32_16x16x32_bf16 v[12:15], v[208:211], v[244:247], v[12:15]
    ds_read_b128 v[68:71], v7 offset:3200
    v_mfma_f32_16x16x32_bf16 v[16:19], v[212:215], v[244:247], v[16:19]
    v_mfma_f32_16x16x32_bf16 v[20:23], v[216:219], v[244:247], v[20:23]
    s_waitcnt lgkmcnt(7)
    v_mfma_f32_16x16x32_bf16 v[12:15], v[220:223], v[248:251], v[12:15]
    ds_read_b128 v[244:247], v8 offset:3072
    v_mfma_f32_16x16x32_bf16 v[16:19], v[224:227], v[248:251], v[16:19]
    v_mfma_f32_16x16x32_bf16 v[20:23], v[228:231], v[248:251], v[20:23]
    s_waitcnt lgkmcnt(7)
    v_mfma_f32_16x16x32_bf16 v[12:15], v[232:235], v[252:255], v[12:15]
    ds_read_b128 v[248:251], v8 offset:3136
    v_mfma_f32_16x16x32_bf16 v[16:19], v[236:239], v[252:255], v[16:19]
    v_mfma_f32_16x16x32_bf16 v[20:23], v[240:243], v[252:255], v[20:23]
    s_waitcnt lgkmcnt(7)
    v_mfma_f32_16x16x32_bf16 v[24:27], a[0:3], v[48:51], 0
    ds_read_b128 v[252:255], v8 offset:3200
    v_mfma_f32_16x16x32_bf16 v[28:31], a[4:7], v[48:51], 0
    v_mfma_f32_16x16x32_bf16 v[32:35], a[8:11], v[48:51], 0
    s_waitcnt lgkmcnt(7)
    v_mfma_f32_16x16x32_bf16 v[24:27], a[12:15], v[52:55], v[24:27]
    ds_read_b128 v[48:51], v6 offset:12672
    v_mfma_f32_16x16x32_bf16 v[28:31], a[16:19], v[52:55], v[28:31]
    v_mfma_f32_16x16x32_bf16 v[32:35], a[20:23], v[52:55], v[32:35]
    s_waitcnt lgkmcnt(7)
    v_mfma_f32_16x16x32_bf16 v[24:27], a[24:27], v[56:59], v[24:27]
    ds_read_b128 v[52:55], v6 offset:12736
    v_mfma_f32_16x16x32_bf16 v[28:31], a[28:31], v[56:59], v[28:31]
    v_mfma_f32_16x16x32_bf16 v[32:35], a[32:35], v[56:59], v[32:35]
    s_waitcnt lgkmcnt(7)
    v_mfma_f32_16x16x32_bf16 v[24:27], a[36:39], v[60:63], v[24:27]
    ds_read_b128 v[56:59], v6 offset:12800
    v_mfma_f32_16x16x32_bf16 v[28:31], a[40:43], v[60:63], v[28:31]
    v_cvt_pk_bf16_f32 v12, v12, v13
    v_mfma_f32_16x16x32_bf16 v[32:35], a[44:47], v[60:63], v[32:35]
    v_cvt_pk_bf16_f32 v13, v14, v15
    s_waitcnt lgkmcnt(7)
    v_mfma_f32_16x16x32_bf16 v[24:27], a[48:51], v[64:67], v[24:27]
    ds_read_b128 v[60:63], v7 offset:12672
    v_mfma_f32_16x16x32_bf16 v[28:31], a[52:55], v[64:67], v[28:31]
    v_cvt_pk_bf16_f32 v14, v16, v17
    v_mfma_f32_16x16x32_bf16 v[32:35], a[56:59], v[64:67], v[32:35]
    v_cvt_pk_bf16_f32 v15, v18, v19
    s_waitcnt lgkmcnt(7)
    v_mfma_f32_16x16x32_bf16 v[24:27], a[60:63], v[68:71], v[24:27]
    ds_read_b128 v[64:67], v7 offset:12736
    v_mfma_f32_16x16x32_bf16 v[28:31], a[64:67], v[68:71], v[28:31]
    buffer_store_dwordx4 v[12:15], v5, s[20:23], s34 offen
    v_mfma_f32_16x16x32_bf16 v[32:35], a[68:71], v[68:71], v[32:35]
    s_waitcnt lgkmcnt(7)
    v_mfma_f32_16x16x32_bf16 v[24:27], a[72:75], v[244:247], v[24:27]
    ds_read_b128 v[68:71], v7 offset:12800
    v_mfma_f32_16x16x32_bf16 v[28:31], a[76:79], v[244:247], v[28:31]
    v_mfma_f32_16x16x32_bf16 v[32:35], a[80:83], v[244:247], v[32:35]
    s_waitcnt lgkmcnt(7)
    v_mfma_f32_16x16x32_bf16 v[24:27], a[84:87], v[248:251], v[24:27]
    ds_read_b128 v[244:247], v8 offset:12672
    v_mfma_f32_16x16x32_bf16 v[28:31], a[88:91], v[248:251], v[28:31]
    v_cvt_pk_bf16_f32 v20, v20, v21
    v_mfma_f32_16x16x32_bf16 v[32:35], a[92:95], v[248:251], v[32:35]
    v_cvt_pk_bf16_f32 v21, v22, v23
    s_waitcnt lgkmcnt(7)
    v_mfma_f32_16x16x32_bf16 v[24:27], a[96:99], v[252:255], v[24:27]
    ds_read_b128 v[248:251], v8 offset:12736
    v_mfma_f32_16x16x32_bf16 v[28:31], a[100:103], v[252:255], v[28:31]
    buffer_store_dwordx2 v[20:21], v2, s[20:23], s34 offen
    v_mfma_f32_16x16x32_bf16 v[32:35], a[104:107], v[252:255], v[32:35]
    s_waitcnt lgkmcnt(7)
    v_mfma_f32_16x16x32_bf16 v[24:27], a[108:111], v[48:51], v[24:27]
    ds_read_b128 v[252:255], v8 offset:12800
    v_mfma_f32_16x16x32_bf16 v[28:31], a[112:115], v[48:51], v[28:31]
    s_add_u32 s34, s34, s57
    v_mfma_f32_16x16x32_bf16 v[32:35], a[116:119], v[48:51], v[32:35]
    s_waitcnt lgkmcnt(7)
    v_mfma_f32_16x16x32_bf16 v[24:27], a[120:123], v[52:55], v[24:27]
    ds_read_b128 v[48:51], v6 offset:22272
    v_mfma_f32_16x16x32_bf16 v[28:31], a[124:127], v[52:55], v[28:31]
    v_mfma_f32_16x16x32_bf16 v[32:35], a[128:131], v[52:55], v[32:35]
    s_waitcnt lgkmcnt(7)
    v_mfma_f32_16x16x32_bf16 v[24:27], a[132:135], v[56:59], v[24:27]
    ds_read_b128 v[52:55], v6 offset:22336
    v_mfma_f32_16x16x32_bf16 v[28:31], a[136:139], v[56:59], v[28:31]
    v_mfma_f32_16x16x32_bf16 v[32:35], a[140:143], v[56:59], v[32:35]
    s_waitcnt lgkmcnt(7)
    v_mfma_f32_16x16x32_bf16 v[24:27], a[144:147], v[60:63], v[24:27]
    ds_read_b128 v[56:59], v6 offset:22400
    v_mfma_f32_16x16x32_bf16 v[28:31], a[148:151], v[60:63], v[28:31]
    v_mfma_f32_16x16x32_bf16 v[32:35], a[152:155], v[60:63], v[32:35]
    s_waitcnt lgkmcnt(7)
    v_mfma_f32_16x16x32_bf16 v[24:27], a[156:159], v[64:67], v[24:27]
    ds_read_b128 v[60:63], v7 offset:22272
    v_mfma_f32_16x16x32_bf16 v[28:31], a[160:163], v[64:67], v[28:31]
    v_mfma_f32_16x16x32_bf16 v[32:35], a[164:167], v[64:67], v[32:35]
    s_waitcnt lgkmcnt(7)
    v_mfma_f32_16x16x32_bf16 v[24:27], a[168:171], v[68:71], v[24:27]
    ds_read_b128 v[64:67], v7 offset:22336
    v_mfma_f32_16x16x32_bf16 v[28:31], a[172:175], v[68:71], v[28:31]
    v_mfma_f32_16x16x32_bf16 v[32:35], a[176:179], v[68:71], v[32:35]
    s_waitcnt lgkmcnt(7)
    v_mfma_f32_16x16x32_bf16 v[24:27], a[180:183], v[244:247], v[24:27]
    ds_read_b128 v[68:71], v7 offset:22400
    v_mfma_f32_16x16x32_bf16 v[28:31], a[184:187], v[244:247], v[28:31]
    v_mfma_f32_16x16x32_bf16 v[32:35], a[188:191], v[244:247], v[32:35]
    s_waitcnt lgkmcnt(7)
    v_mfma_f32_16x16x32_bf16 v[24:27], a[192:195], v[248:251], v[24:27]
    ds_read_b128 v[244:247], v8 offset:22272
    v_mfma_f32_16x16x32_bf16 v[28:31], a[196:199], v[248:251], v[28:31]
    v_mfma_f32_16x16x32_bf16 v[32:35], a[200:203], v[248:251], v[32:35]
    s_waitcnt lgkmcnt(7)
    v_mfma_f32_16x16x32_bf16 v[24:27], a[204:207], v[252:255], v[24:27]
    ds_read_b128 v[248:251], v8 offset:22336
    v_mfma_f32_16x16x32_bf16 v[28:31], a[208:211], v[252:255], v[28:31]
    v_mfma_f32_16x16x32_bf16 v[32:35], a[212:215], v[252:255], v[32:35]
    s_waitcnt lgkmcnt(7)
    v_mfma_f32_16x16x32_bf16 v[24:27], a[216:219], v[48:51], v[24:27]
    ds_read_b128 v[252:255], v8 offset:22400
    v_mfma_f32_16x16x32_bf16 v[28:31], a[220:223], v[48:51], v[28:31]
    v_mfma_f32_16x16x32_bf16 v[32:35], a[224:227], v[48:51], v[32:35]
    s_waitcnt lgkmcnt(7)
    v_mfma_f32_16x16x32_bf16 v[24:27], a[228:231], v[52:55], v[24:27]
    ds_read_b128 v[48:51], v6 offset:6144
    v_mfma_f32_16x16x32_bf16 v[28:31], a[232:235], v[52:55], v[28:31]
    v_mfma_f32_16x16x32_bf16 v[32:35], a[236:239], v[52:55], v[32:35]
    s_waitcnt lgkmcnt(7)
    v_mfma_f32_16x16x32_bf16 v[24:27], a[240:243], v[56:59], v[24:27]
    ds_read_b128 v[52:55], v6 offset:6208
    v_mfma_f32_16x16x32_bf16 v[28:31], a[244:247], v[56:59], v[28:31]
    v_mfma_f32_16x16x32_bf16 v[32:35], a[248:251], v[56:59], v[32:35]
    s_waitcnt lgkmcnt(7)
    v_mfma_f32_16x16x32_bf16 v[24:27], a[252:255], v[60:63], v[24:27]
    ds_read_b128 v[56:59], v6 offset:6272
    v_mfma_f32_16x16x32_bf16 v[28:31], v[176:179], v[60:63], v[28:31]
    v_mfma_f32_16x16x32_bf16 v[32:35], v[180:183], v[60:63], v[32:35]
    s_waitcnt lgkmcnt(7)
    v_mfma_f32_16x16x32_bf16 v[24:27], v[184:187], v[64:67], v[24:27]
    ds_read_b128 v[60:63], v7 offset:6144
    v_mfma_f32_16x16x32_bf16 v[28:31], v[188:191], v[64:67], v[28:31]
    v_mfma_f32_16x16x32_bf16 v[32:35], v[192:195], v[64:67], v[32:35]
    s_waitcnt lgkmcnt(7)
    v_mfma_f32_16x16x32_bf16 v[24:27], v[196:199], v[68:71], v[24:27]
    ds_read_b128 v[64:67], v7 offset:6208
    v_mfma_f32_16x16x32_bf16 v[28:31], v[200:203], v[68:71], v[28:31]
    v_mfma_f32_16x16x32_bf16 v[32:35], v[204:207], v[68:71], v[32:35]
    s_waitcnt lgkmcnt(7)
    v_mfma_f32_16x16x32_bf16 v[24:27], v[208:211], v[244:247], v[24:27]
    ds_read_b128 v[68:71], v7 offset:6272
    v_mfma_f32_16x16x32_bf16 v[28:31], v[212:215], v[244:247], v[28:31]
    v_mfma_f32_16x16x32_bf16 v[32:35], v[216:219], v[244:247], v[32:35]
    s_waitcnt lgkmcnt(7)
    v_mfma_f32_16x16x32_bf16 v[24:27], v[220:223], v[248:251], v[24:27]
    ds_read_b128 v[244:247], v8 offset:6144
    v_mfma_f32_16x16x32_bf16 v[28:31], v[224:227], v[248:251], v[28:31]
    v_mfma_f32_16x16x32_bf16 v[32:35], v[228:231], v[248:251], v[32:35]
    s_waitcnt lgkmcnt(7)
    v_mfma_f32_16x16x32_bf16 v[24:27], v[232:235], v[252:255], v[24:27]
    ds_read_b128 v[248:251], v8 offset:6208
    v_mfma_f32_16x16x32_bf16 v[28:31], v[236:239], v[252:255], v[28:31]
    v_mfma_f32_16x16x32_bf16 v[32:35], v[240:243], v[252:255], v[32:35]
    s_waitcnt lgkmcnt(7)
    v_mfma_f32_16x16x32_bf16 v[36:39], a[0:3], v[48:51], 0
    ds_read_b128 v[252:255], v8 offset:6272
    v_mfma_f32_16x16x32_bf16 v[40:43], a[4:7], v[48:51], 0
    v_mfma_f32_16x16x32_bf16 v[44:47], a[8:11], v[48:51], 0
    s_waitcnt lgkmcnt(7)
    v_mfma_f32_16x16x32_bf16 v[36:39], a[12:15], v[52:55], v[36:39]
    ds_read_b128 v[48:51], v6 offset:15744
    v_mfma_f32_16x16x32_bf16 v[40:43], a[16:19], v[52:55], v[40:43]
    v_mfma_f32_16x16x32_bf16 v[44:47], a[20:23], v[52:55], v[44:47]
    s_waitcnt lgkmcnt(7)
    v_mfma_f32_16x16x32_bf16 v[36:39], a[24:27], v[56:59], v[36:39]
    ds_read_b128 v[52:55], v6 offset:15808
    v_mfma_f32_16x16x32_bf16 v[40:43], a[28:31], v[56:59], v[40:43]
    v_mfma_f32_16x16x32_bf16 v[44:47], a[32:35], v[56:59], v[44:47]
    s_waitcnt lgkmcnt(7)
    v_mfma_f32_16x16x32_bf16 v[36:39], a[36:39], v[60:63], v[36:39]
    ds_read_b128 v[56:59], v6 offset:15872
    v_mfma_f32_16x16x32_bf16 v[40:43], a[40:43], v[60:63], v[40:43]
    v_cvt_pk_bf16_f32 v24, v24, v25
    v_mfma_f32_16x16x32_bf16 v[44:47], a[44:47], v[60:63], v[44:47]
    v_cvt_pk_bf16_f32 v25, v26, v27
    s_waitcnt lgkmcnt(7)
    v_mfma_f32_16x16x32_bf16 v[36:39], a[48:51], v[64:67], v[36:39]
    ds_read_b128 v[60:63], v7 offset:15744
    v_mfma_f32_16x16x32_bf16 v[40:43], a[52:55], v[64:67], v[40:43]
    v_cvt_pk_bf16_f32 v26, v28, v29
    v_mfma_f32_16x16x32_bf16 v[44:47], a[56:59], v[64:67], v[44:47]
    v_cvt_pk_bf16_f32 v27, v30, v31
    s_waitcnt lgkmcnt(7)
    v_mfma_f32_16x16x32_bf16 v[36:39], a[60:63], v[68:71], v[36:39]
    ds_read_b128 v[64:67], v7 offset:15808
    v_mfma_f32_16x16x32_bf16 v[40:43], a[64:67], v[68:71], v[40:43]
    buffer_store_dwordx4 v[24:27], v5, s[20:23], s35 offen
    v_mfma_f32_16x16x32_bf16 v[44:47], a[68:71], v[68:71], v[44:47]
    s_waitcnt lgkmcnt(7)
    v_mfma_f32_16x16x32_bf16 v[36:39], a[72:75], v[244:247], v[36:39]
    ds_read_b128 v[68:71], v7 offset:15872
    v_mfma_f32_16x16x32_bf16 v[40:43], a[76:79], v[244:247], v[40:43]
    v_mfma_f32_16x16x32_bf16 v[44:47], a[80:83], v[244:247], v[44:47]
    s_waitcnt lgkmcnt(7)
    v_mfma_f32_16x16x32_bf16 v[36:39], a[84:87], v[248:251], v[36:39]
    ds_read_b128 v[244:247], v8 offset:15744
    v_mfma_f32_16x16x32_bf16 v[40:43], a[88:91], v[248:251], v[40:43]
    v_cvt_pk_bf16_f32 v32, v32, v33
    v_mfma_f32_16x16x32_bf16 v[44:47], a[92:95], v[248:251], v[44:47]
    v_cvt_pk_bf16_f32 v33, v34, v35
    s_waitcnt lgkmcnt(7)
    v_mfma_f32_16x16x32_bf16 v[36:39], a[96:99], v[252:255], v[36:39]
    ds_read_b128 v[248:251], v8 offset:15808
    v_mfma_f32_16x16x32_bf16 v[40:43], a[100:103], v[252:255], v[40:43]
    buffer_store_dwordx2 v[32:33], v2, s[20:23], s35 offen
    v_mfma_f32_16x16x32_bf16 v[44:47], a[104:107], v[252:255], v[44:47]
    s_waitcnt lgkmcnt(7)
    v_mfma_f32_16x16x32_bf16 v[36:39], a[108:111], v[48:51], v[36:39]
    ds_read_b128 v[252:255], v8 offset:15872
    v_mfma_f32_16x16x32_bf16 v[40:43], a[112:115], v[48:51], v[40:43]
    s_add_u32 s35, s35, s57
    v_mfma_f32_16x16x32_bf16 v[44:47], a[116:119], v[48:51], v[44:47]
    s_waitcnt lgkmcnt(7)
    v_mfma_f32_16x16x32_bf16 v[36:39], a[120:123], v[52:55], v[36:39]
    ds_read_b128 v[48:51], v6 offset:25344
    v_mfma_f32_16x16x32_bf16 v[40:43], a[124:127], v[52:55], v[40:43]
    v_mfma_f32_16x16x32_bf16 v[44:47], a[128:131], v[52:55], v[44:47]
    s_waitcnt lgkmcnt(7)
    v_mfma_f32_16x16x32_bf16 v[36:39], a[132:135], v[56:59], v[36:39]
    ds_read_b128 v[52:55], v6 offset:25408
    v_mfma_f32_16x16x32_bf16 v[40:43], a[136:139], v[56:59], v[40:43]
    v_mfma_f32_16x16x32_bf16 v[44:47], a[140:143], v[56:59], v[44:47]
    s_waitcnt lgkmcnt(7)
    v_mfma_f32_16x16x32_bf16 v[36:39], a[144:147], v[60:63], v[36:39]
    ds_read_b128 v[56:59], v6 offset:25472
    v_mfma_f32_16x16x32_bf16 v[40:43], a[148:151], v[60:63], v[40:43]
    v_mfma_f32_16x16x32_bf16 v[44:47], a[152:155], v[60:63], v[44:47]
    s_waitcnt lgkmcnt(7)
    v_mfma_f32_16x16x32_bf16 v[36:39], a[156:159], v[64:67], v[36:39]
    ds_read_b128 v[60:63], v7 offset:25344
    v_mfma_f32_16x16x32_bf16 v[40:43], a[160:163], v[64:67], v[40:43]
    v_mfma_f32_16x16x32_bf16 v[44:47], a[164:167], v[64:67], v[44:47]
    s_waitcnt lgkmcnt(7)
    v_mfma_f32_16x16x32_bf16 v[36:39], a[168:171], v[68:71], v[36:39]
    ds_read_b128 v[64:67], v7 offset:25408
    v_mfma_f32_16x16x32_bf16 v[40:43], a[172:175], v[68:71], v[40:43]
    v_mfma_f32_16x16x32_bf16 v[44:47], a[176:179], v[68:71], v[44:47]
    s_waitcnt lgkmcnt(7)
    v_mfma_f32_16x16x32_bf16 v[36:39], a[180:183], v[244:247], v[36:39]
    ds_read_b128 v[68:71], v7 offset:25472
    v_mfma_f32_16x16x32_bf16 v[40:43], a[184:187], v[244:247], v[40:43]
    v_mfma_f32_16x16x32_bf16 v[44:47], a[188:191], v[244:247], v[44:47]
    s_waitcnt lgkmcnt(7)
    v_mfma_f32_16x16x32_bf16 v[36:39], a[192:195], v[248:251], v[36:39]
    ds_read_b128 v[244:247], v8 offset:25344
    v_mfma_f32_16x16x32_bf16 v[40:43], a[196:199], v[248:251], v[40:43]
    v_mfma_f32_16x16x32_bf16 v[44:47], a[200:203], v[248:251], v[44:47]
    s_waitcnt lgkmcnt(7)
    v_mfma_f32_16x16x32_bf16 v[36:39], a[204:207], v[252:255], v[36:39]
    ds_read_b128 v[248:251], v8 offset:25408
    v_mfma_f32_16x16x32_bf16 v[40:43], a[208:211], v[252:255], v[40:43]
    v_mfma_f32_16x16x32_bf16 v[44:47], a[212:215], v[252:255], v[44:47]
    s_waitcnt lgkmcnt(7)
    v_mfma_f32_16x16x32_bf16 v[36:39], a[216:219], v[48:51], v[36:39]
    ds_read_b128 v[252:255], v8 offset:25472
    v_mfma_f32_16x16x32_bf16 v[40:43], a[220:223], v[48:51], v[40:43]
    v_mfma_f32_16x16x32_bf16 v[44:47], a[224:227], v[48:51], v[44:47]
    s_waitcnt lgkmcnt(7)
    v_mfma_f32_16x16x32_bf16 v[36:39], a[228:231], v[52:55], v[36:39]
    v_mfma_f32_16x16x32_bf16 v[40:43], a[232:235], v[52:55], v[40:43]
    v_mfma_f32_16x16x32_bf16 v[44:47], a[236:239], v[52:55], v[44:47]
    s_waitcnt lgkmcnt(6)
    v_mfma_f32_16x16x32_bf16 v[36:39], a[240:243], v[56:59], v[36:39]
    v_mfma_f32_16x16x32_bf16 v[40:43], a[244:247], v[56:59], v[40:43]
    v_mfma_f32_16x16x32_bf16 v[44:47], a[248:251], v[56:59], v[44:47]
    s_waitcnt lgkmcnt(5)
    v_mfma_f32_16x16x32_bf16 v[36:39], a[252:255], v[60:63], v[36:39]
    v_mfma_f32_16x16x32_bf16 v[40:43], v[176:179], v[60:63], v[40:43]
    v_mfma_f32_16x16x32_bf16 v[44:47], v[180:183], v[60:63], v[44:47]
    s_waitcnt lgkmcnt(4)
    v_mfma_f32_16x16x32_bf16 v[36:39], v[184:187], v[64:67], v[36:39]
    v_mfma_f32_16x16x32_bf16 v[40:43], v[188:191], v[64:67], v[40:43]
    v_mfma_f32_16x16x32_bf16 v[44:47], v[192:195], v[64:67], v[44:47]
    s_waitcnt lgkmcnt(3)
    v_mfma_f32_16x16x32_bf16 v[36:39], v[196:199], v[68:71], v[36:39]
    v_mfma_f32_16x16x32_bf16 v[40:43], v[200:203], v[68:71], v[40:43]
    v_mfma_f32_16x16x32_bf16 v[44:47], v[204:207], v[68:71], v[44:47]
    s_waitcnt lgkmcnt(2)
    v_mfma_f32_16x16x32_bf16 v[36:39], v[208:211], v[244:247], v[36:39]
    v_mfma_f32_16x16x32_bf16 v[40:43], v[212:215], v[244:247], v[40:43]
    v_mfma_f32_16x16x32_bf16 v[44:47], v[216:219], v[244:247], v[44:47]
    s_waitcnt lgkmcnt(1)
    v_mfma_f32_16x16x32_bf16 v[36:39], v[220:223], v[248:251], v[36:39]
    v_mfma_f32_16x16x32_bf16 v[40:43], v[224:227], v[248:251], v[40:43]
    v_mfma_f32_16x16x32_bf16 v[44:47], v[228:231], v[248:251], v[44:47]
    s_waitcnt lgkmcnt(0)
    v_mfma_f32_16x16x32_bf16 v[36:39], v[232:235], v[252:255], v[36:39]
    v_mfma_f32_16x16x32_bf16 v[40:43], v[236:239], v[252:255], v[40:43]
    v_mfma_f32_16x16x32_bf16 v[44:47], v[240:243], v[252:255], v[44:47]
    s_nop 7
    v_cvt_pk_bf16_f32 v36, v36, v37
    v_cvt_pk_bf16_f32 v37, v38, v39
    v_cvt_pk_bf16_f32 v38, v40, v41
    v_cvt_pk_bf16_f32 v39, v42, v43
    buffer_store_dwordx4 v[36:39], v5, s[20:23], s36 offen
    v_cvt_pk_bf16_f32 v44, v44, v45
    v_cvt_pk_bf16_f32 v45, v46, v47
    buffer_store_dwordx2 v[44:45], v2, s[20:23], s36 offen
L_end:
    s_endpgm
.section .rodata,"a"
.p2align 6
.amdhsa_kernel standalone__detection_seg_fpn_lateral__vision_kernel
  .amdhsa_next_free_vgpr 512
  .amdhsa_next_free_sgpr 102
  .amdhsa_accum_offset 256
  .amdhsa_group_segment_fixed_size 0
  .amdhsa_kernarg_size 56
  .amdhsa_user_sgpr_count 2
  .amdhsa_user_sgpr_kernarg_segment_ptr 1
  .amdhsa_system_sgpr_workgroup_id_x 1
.end_amdhsa_kernel
```
